```python
import torch

def _softmax(x, axis=-1):
    return torch.softmax(x, dim=axis)
def _gelu(x):
    return torch.nn.functional.gelu(x, approximate="tanh")
def _silu(x):
    return torch.nn.functional.silu(x)
def _sigmoid(x):
    return torch.sigmoid(x)
def _layernorm(x, axis=-1, eps=1e-5):
    m = x.mean(dim=axis, keepdim=True)
    v = x.var(dim=axis, keepdim=True, unbiased=False)
    return (x - m) / torch.sqrt(v + eps)
def _scatter_add(tgt, idx, src, axis=0):
    return tgt.clone().index_add_(axis, idx, src)
def _segment_sum(src, seg, n):
    out = torch.zeros((n,) + src.shape[1:], dtype=src.dtype)
    return out.index_add_(0, seg, src)
def _pad(x, pw):
    flat = tuple(v for pair in reversed(pw) for v in pair)
    return torch.nn.functional.pad(x, flat)

kernel_name = 'gated_mix__sliding_block__softmax_full_mha__prompt'

def setup_inputs():

    _w = (lambda a: (lambda t: t.to(torch.bfloat16) if t.is_floating_point() else t)(torch.as_tensor(a)))
    def _A_setup():
        B, S, D = 1, 2048, 512
        return {
            "x": _w((lambda *s: torch.randn(*s, dtype=torch.bfloat16) * 0.05)(B, S, D)),
            "wqkv": _w((lambda *s: torch.randn(*s, dtype=torch.bfloat16) * 1.6)(D, 3 * D)),
            "wo": _w((lambda *s: torch.randn(*s, dtype=torch.bfloat16) * 0.05)(D, D)),
        }
    _A_in = _A_setup()

    def _B_setup():
        B, S, D = 1, 2048, 512
        return {
            "x": _w((lambda *s: torch.randn(*s, dtype=torch.bfloat16) * 0.05)(B, S, D)),
            "wqkv": _w((lambda *s: torch.randn(*s, dtype=torch.bfloat16) * 1.6)(D, 3 * D)),
            "wo": _w((lambda *s: torch.randn(*s, dtype=torch.bfloat16) * 0.1)(D, D)),
        }
    _B_in = _B_setup()

    return {
        "A_x": _A_in["x"],
        "A_wqkv": _A_in["wqkv"],
        "A_wo": _A_in["wo"],
        "B_x": _B_in["x"],
        "B_wqkv": _B_in["wqkv"],
        "B_wo": _B_in["wo"],
        "gate_w": _w((lambda *s: torch.randn(*s, dtype=torch.bfloat16) * 0.05)(512) * 16.0),
    }

def reference(A_x, A_wqkv, A_wo, B_x, B_wqkv, B_wo, gate_w):
    def _A_ref(x, wqkv, wo):
        B, S, D = x.shape
        H = 32; Dh = D // H; W = 256
        qkv = (lambda x, *d: x.permute(*d))((x @ wqkv).reshape(B, S, 3, H, Dh), 2, 0, 3, 1, 4)
        q, k, v = qkv[0], qkv[1], qkv[2]
        scores = torch.einsum("bhqd,bhkd->bhqk", q, k) * (Dh ** -0.5)
        idx = torch.arange(S)
        mask = (idx[:, None] - idx[None, :] >= 0) & (idx[:, None] - idx[None, :] < W)
        scores = torch.where(mask[None, None], scores, -1e9)
        p = _softmax(scores, axis=-1)
        o = torch.einsum("bhqk,bhkd->bhqd", p, v)
        return (lambda x, *d: x.permute(*d))(o, 0, 2, 1, 3).reshape(B, S, D) @ wo

    def _B_ref(x, wqkv, wo):
        B, S, D = x.shape
        H = 32; Dh = D // H
        qkv = (lambda x, *d: x.permute(*d))((x @ wqkv).reshape(B, S, 3, H, Dh), 2, 0, 3, 1, 4)
        q, k, v = qkv[0], qkv[1], qkv[2]
        scale = Dh ** -0.5
        scores = torch.einsum("bhqd,bhkd->bhqk", q, k) * scale
        p = _softmax(scores, axis=-1)
        o = torch.einsum("bhqk,bhkd->bhqd", p, v)
        return (lambda x, *d: x.permute(*d))(o, 0, 2, 1, 3).reshape(B, S, D) @ wo

    x = A_x
    g = _sigmoid((x * gate_w).sum(-1, keepdims=True))
    a = _A_ref(x, A_wqkv, A_wo)
    b = _B_ref(x, B_wqkv, B_wo)
    return g * a + (1 - g) * b
```

```asm
; @launch grid=(256,1,1) block=(512,1,1) lds=163840
.amdgcn_target "amdgcn-amd-amdhsa--gfx950"
.text
.set CODE_LEFT, L_END - L_CONS - 64
.globl gated_mix__sliding_block__softmax_full_mha__prompt_kernel
.p2align 12
.p2align 8
.type gated_mix__sliding_block__softmax_full_mha__prompt_kernel,@function
gated_mix__sliding_block__softmax_full_mha__prompt_kernel:
    s_load_dwordx16 s[64:79], s[0:1], 0
    s_load_dwordx4 s[80:83], s[0:1], 64
    v_lshrrev_b32 v1, 6, v0
    s_cmp_ge_u32 s2, 256
    s_cbranch_scc1 L_END
    v_readfirstlane_b32 s3, v1
    v_and_b32 v0, 63, v0
    s_and_b32 s5, s2, 7
    s_lshr_b32 s4, s2, 4
    s_bfe_u32 s6, s2, 0x10003
    s_cmp_ge_u32 s3, 4
    s_cbranch_scc0 L_CONS
    s_and_b32 s84, s3, 3
    s_lshl_b32 s60, s6, 2
    s_add_u32 s7, s4, s60
    s_add_u32 s7, s7, s5
    s_and_b32 s7, s7, 7
    v_lshrrev_b32 v1, 3, v0
    v_bfe_u32 v3, v0, 4, 2
    v_xor_b32 v4, v0, v3
    v_and_b32 v4, 7, v4
    v_lshlrev_b32 v4, 4, v4
    v_lshl_add_u32 v4, v1, 10, v4
    s_lshl_b32 s85, s4, 17
    s_lshl_b32 s86, s84, 15
    s_add_u32 s85, s85, s86
    v_add_u32 v8, s85, v4
    v_xor_b32 v9, 64, v8
    v_add_u32 v9, 7168, v9
    v_add_u32 v10, 14336, v8
    v_add_u32 v11, 14336, v9
    v_bfe_u32 v3, v0, 4, 1
    v_lshlrev_b32 v3, 2, v3
    v_xor_b32 v3, v0, v3
    v_and_b32 v3, 7, v3
    v_lshlrev_b32 v3, 4, v3
    v_mul_u32_u24 v5, 3072, v1
    s_lshl_b32 s86, s5, 7
    v_add3_u32 v12, v3, v5, s86
    v_add_u32 v13, 23552, v12
    v_add_u32 v14, 47104, v12
    v_add_u32 v15, 70656, v12
    s_lshl_b32 s88, s6, 10
    s_add_u32 s88, s88, 1024
    s_and_b32 s86, s84, 1
    s_mul_i32 s86, s86, 98304
    s_cmp_lt_u32 s84, 2
    s_cselect_b32 s85, s88, 0
    s_add_u32 s85, s85, s86
    s_lshl_b32 s87, s84, 12
    s_lshr_b32 s86, s84, 1
    s_and_b32 s86, s86, s6
    s_mov_b32 s18, 0x200000
    s_mov_b32 s19, 0x20000
    s_mov_b32 s22, 0x180000
    s_mov_b32 s23, 0x20000
    s_mov_b32 s89, s7
    s_waitcnt lgkmcnt(0)
    s_mov_b32 s16, s64
    s_mov_b32 s17, s65
    s_cmp_eq_u32 s86, 0
    s_cselect_b32 s20, s72, s66
    s_cselect_b32 s21, s73, s67
    s_add_u32 m0, s87, 98304
    s_lshl_b32 s90, s89, 7
    buffer_load_dwordx4 v8, s[16:19], s90 offen offset:0 lds
    buffer_load_dwordx4 v9, s[16:19], s90 offen offset:1024 lds
    buffer_load_dwordx4 v10, s[16:19], s90 offen offset:2048 lds
    buffer_load_dwordx4 v11, s[16:19], s90 offen offset:3072 lds
    s_mul_i32 s90, s89, 196608
    s_add_u32 m0, s87, 114688
    s_add_u32 s90, s90, s85
    buffer_load_dwordx4 v12, s[20:23], s90 offen offset:0 lds
    buffer_load_dwordx4 v13, s[20:23], s90 offen offset:1024 lds
    buffer_load_dwordx4 v14, s[20:23], s90 offen offset:2048 lds
    buffer_load_dwordx4 v15, s[20:23], s90 offen offset:3072 lds
    s_add_u32 s89, s89, 1
    s_and_b32 s89, s89, 7
    s_add_u32 m0, s87, 65536
    s_lshl_b32 s90, s89, 7
    buffer_load_dwordx4 v8, s[16:19], s90 offen offset:0 lds
    buffer_load_dwordx4 v9, s[16:19], s90 offen offset:1024 lds
    buffer_load_dwordx4 v10, s[16:19], s90 offen offset:2048 lds
    buffer_load_dwordx4 v11, s[16:19], s90 offen offset:3072 lds
    s_mul_i32 s90, s89, 196608
    s_add_u32 m0, s87, 81920
    s_add_u32 s90, s90, s85
    buffer_load_dwordx4 v12, s[20:23], s90 offen offset:0 lds
    buffer_load_dwordx4 v13, s[20:23], s90 offen offset:1024 lds
    buffer_load_dwordx4 v14, s[20:23], s90 offen offset:2048 lds
    buffer_load_dwordx4 v15, s[20:23], s90 offen offset:3072 lds
    s_add_u32 s89, s89, 1
    s_and_b32 s89, s89, 7
    s_branch L_LOAD2
L_CONS:
    s_getpc_b64 s[86:87]
    s_lshr_b32 s88, s2, 3
    s_lshl_b32 s88, s88, 2
    s_add_u32 s88, s88, s3
    s_mul_i32 s88, s88, 384
    s_mov_b32 s89, CODE_LEFT
    s_mov_b64 exec, 7
    v_mul_u32_u24 v24, 128, v0
    v_add_u32 v24, s88, v24
    v_min_u32 v24, s89, v24
    v_mov_b32 v25, s87
    v_add_co_u32 v24, vcc, s86, v24
    s_nop 1
    v_addc_co_u32 v25, vcc, 0, v25, vcc
    global_load_dword v249, v[24:25], off
    s_mov_b64 exec, -1
    s_lshr_b32 s61, s3, 1
    s_and_b32 s15, s3, 1
    s_lshl_b32 s15, s15, 1
    s_add_u32 s15, s15, s61
    v_and_b32 v1, 31, v0
    v_lshrrev_b32 v25, 5, v0
    v_bfe_u32 v3, v0, 1, 3
    v_xor_b32 v26, v25, v3
    v_lshlrev_b32 v26, 4, v26
    v_lshl_add_u32 v26, v1, 7, v26
    s_lshl_b32 s86, s15, 12
    s_add_u32 s86, s86, 98304
    v_add_u32 v4, s86, v26
    v_xor_b32 v5, 32, v4
    v_xor_b32 v6, 64, v4
    v_xor_b32 v7, 96, v4
    v_xor_b32 v16, 0x1000, v4
    v_xor_b32 v17, 0x1000, v5
    v_xor_b32 v18, 0x1000, v6
    v_xor_b32 v19, 0x1000, v7
    v_bfe_u32 v26, v0, 2, 2
    v_lshl_add_u32 v26, v25, 3, v26
    v_lshlrev_b32 v26, 7, v26
    v_bfe_u32 v27, v0, 4, 1
    v_lshlrev_b32 v27, 1, v27
    v_bfe_u32 v28, v0, 1, 1
    v_or_b32 v27, v27, v28
    v_bfe_u32 v28, v0, 3, 1
    v_lshl_or_b32 v27, v28, 2, v27
    v_lshl_add_u32 v26, v27, 4, v26
    v_and_b32 v28, 1, v0
    v_lshl_add_u32 v8, v28, 3, v26
    v_xor_b32 v9, 64, v8
    s_lshl_b32 s86, s61, 13
    s_add_u32 s86, s86, 114688
    v_add_u32 v10, s86, v8
    v_add_u32 v11, s86, v9
    v_lshlrev_b32 v14, 4, v25
    v_mov_b32 v13, 0
    s_waitcnt lgkmcnt(0)
    s_mov_b32 s52, s80
    s_mov_b32 s53, s81
    s_mov_b32 s54, 0x100
    s_mov_b32 s55, 0x20000
    s_or_b32 s86, s3, s2
    s_cmp_lg_u32 s86, 0
    s_cbranch_scc1 Lnn_1
    s_memrealtime s[86:87]
    s_waitcnt lgkmcnt(0)
    s_or_b32 s86, s86, 1
    v_mov_b32 v20, s86
    v_mov_b32 v21, s87
    s_mov_b64 exec, 1
    buffer_store_dwordx2 v[20:21], v13, s[52:55], 0 offen sc1
    s_mov_b64 exec, -1
Lnn_1:
    s_cmp_lg_u32 s3, 3
    s_cbranch_scc1 Ltc_2
    s_call_b64 s[100:101], PG_C0A31
    s_call_b64 s[100:101], PG_P24
    s_call_b64 s[100:101], PG_K
Ltc_2:
    s_cmp_lg_u32 s3, 2
    s_cbranch_scc1 Ltc_3
    s_call_b64 s[100:101], PG_C1A1
    s_call_b64 s[100:101], PG_P51
Ltc_3:
    s_cmp_lg_u32 s3, 1
    s_cbranch_scc1 Ltc_4
    s_call_b64 s[100:101], PG_C1A31
    s_call_b64 s[100:101], PG_Pe0
Ltc_4:
    s_cmp_lg_u32 s3, 0
    s_cbranch_scc1 Ltc_5
    s_call_b64 s[100:101], PG_P0
    s_call_b64 s[100:101], PG_J
Ltc_5:
    s_cmp_gt_u32 s6, s61
    s_cbranch_scc1 L_AN
    s_branch L_AT
L_LOAD2:
    s_waitcnt vmcnt(8)
    s_barrier
    s_add_u32 m0, s87, 32768
    s_lshl_b32 s90, s89, 7
    buffer_load_dwordx4 v8, s[16:19], s90 offen offset:0 lds
    buffer_load_dwordx4 v9, s[16:19], s90 offen offset:1024 lds
    buffer_load_dwordx4 v10, s[16:19], s90 offen offset:2048 lds
    buffer_load_dwordx4 v11, s[16:19], s90 offen offset:3072 lds
    s_mul_i32 s90, s89, 196608
    s_add_u32 m0, s87, 49152
    s_add_u32 s90, s90, s85
    buffer_load_dwordx4 v12, s[20:23], s90 offen offset:0 lds
    buffer_load_dwordx4 v13, s[20:23], s90 offen offset:1024 lds
    buffer_load_dwordx4 v14, s[20:23], s90 offen offset:2048 lds
    buffer_load_dwordx4 v15, s[20:23], s90 offen offset:3072 lds
    s_add_u32 s89, s89, 1
    s_and_b32 s89, s89, 7
    s_mov_b32 s28, s66
    s_mov_b32 s29, s67
    s_mov_b32 s30, 0x180000
    s_mov_b32 s31, 0x20000
    s_mov_b32 s48, s76
    s_mov_b32 s49, s77
    s_mov_b32 s50, 0x400
    s_mov_b32 s51, 0x20000
    s_mov_b32 s32, s82
    s_mov_b32 s33, s83
    s_mov_b32 s34, 0x1800000
    s_mov_b32 s35, 0x20000
    s_mov_b32 s52, s80
    s_mov_b32 s53, s81
    s_mov_b32 s54, 0x100
    s_mov_b32 s55, 0x20000
    s_mov_b32 s36, s78
    s_mov_b32 s37, s79
    s_mov_b32 s38, 0x200000
    s_mov_b32 s39, 0x20000
    s_mov_b32 s40, s68
    s_mov_b32 s41, s69
    s_mov_b32 s42, 0x80000
    s_mov_b32 s43, 0x20000
    s_mov_b32 s44, s74
    s_mov_b32 s45, s75
    s_mov_b32 s46, 0x80000
    s_mov_b32 s47, 0x20000
    s_lshl_b32 s8, s5, 2
    s_bfe_u32 s60, s2, 0x20003
    s_add_u32 s8, s8, s60
    s_lshr_b32 s9, s2, 5
    s_lshl_b32 s10, s9, 3
    s_add_u32 s10, s10, s3
    s_waitcnt vmcnt(8)
    s_barrier
    s_add_u32 m0, s87, 0
    s_lshl_b32 s90, s89, 7
    buffer_load_dwordx4 v8, s[16:19], s90 offen offset:0 lds
    buffer_load_dwordx4 v9, s[16:19], s90 offen offset:1024 lds
    buffer_load_dwordx4 v10, s[16:19], s90 offen offset:2048 lds
    buffer_load_dwordx4 v11, s[16:19], s90 offen offset:3072 lds
    s_mul_i32 s90, s89, 196608
    s_add_u32 m0, s87, 16384
    s_add_u32 s90, s90, s85
    buffer_load_dwordx4 v12, s[20:23], s90 offen offset:0 lds
    buffer_load_dwordx4 v13, s[20:23], s90 offen offset:1024 lds
    buffer_load_dwordx4 v14, s[20:23], s90 offen offset:2048 lds
    buffer_load_dwordx4 v15, s[20:23], s90 offen offset:3072 lds
    s_add_u32 s89, s89, 1
    s_and_b32 s89, s89, 7
    s_add_u32 m0, s87, 98304
    s_lshl_b32 s90, s89, 7
    buffer_load_dwordx4 v8, s[16:19], s90 offen offset:0 lds
    buffer_load_dwordx4 v9, s[16:19], s90 offen offset:1024 lds
    buffer_load_dwordx4 v10, s[16:19], s90 offen offset:2048 lds
    buffer_load_dwordx4 v11, s[16:19], s90 offen offset:3072 lds
    s_waitcnt vmcnt(12)
    s_barrier
    s_mul_i32 s90, s89, 196608
    s_add_u32 m0, s87, 114688
    s_add_u32 s90, s90, s85
    buffer_load_dwordx4 v12, s[20:23], s90 offen offset:0 lds
    buffer_load_dwordx4 v13, s[20:23], s90 offen offset:1024 lds
    buffer_load_dwordx4 v14, s[20:23], s90 offen offset:2048 lds
    buffer_load_dwordx4 v15, s[20:23], s90 offen offset:3072 lds
    s_add_u32 s89, s89, 1
    s_and_b32 s89, s89, 7
    s_add_u32 m0, s87, 65536
    s_lshl_b32 s90, s89, 7
    buffer_load_dwordx4 v8, s[16:19], s90 offen offset:0 lds
    buffer_load_dwordx4 v9, s[16:19], s90 offen offset:1024 lds
    buffer_load_dwordx4 v10, s[16:19], s90 offen offset:2048 lds
    buffer_load_dwordx4 v11, s[16:19], s90 offen offset:3072 lds
    s_mul_i32 s90, s89, 196608
    s_add_u32 m0, s87, 81920
    s_add_u32 s90, s90, s85
    buffer_load_dwordx4 v12, s[20:23], s90 offen offset:0 lds
    buffer_load_dwordx4 v13, s[20:23], s90 offen offset:1024 lds
    buffer_load_dwordx4 v14, s[20:23], s90 offen offset:2048 lds
    buffer_load_dwordx4 v15, s[20:23], s90 offen offset:3072 lds
    s_add_u32 s89, s89, 1
    s_and_b32 s89, s89, 7
    s_waitcnt vmcnt(16)
    s_barrier
    s_add_u32 m0, s87, 32768
    s_lshl_b32 s90, s89, 7
    buffer_load_dwordx4 v8, s[16:19], s90 offen offset:0 lds
    buffer_load_dwordx4 v9, s[16:19], s90 offen offset:1024 lds
    buffer_load_dwordx4 v10, s[16:19], s90 offen offset:2048 lds
    buffer_load_dwordx4 v11, s[16:19], s90 offen offset:3072 lds
    s_mul_i32 s90, s89, 196608
    s_add_u32 m0, s87, 49152
    s_add_u32 s90, s90, s85
    buffer_load_dwordx4 v12, s[20:23], s90 offen offset:0 lds
    buffer_load_dwordx4 v13, s[20:23], s90 offen offset:1024 lds
    buffer_load_dwordx4 v14, s[20:23], s90 offen offset:2048 lds
    buffer_load_dwordx4 v15, s[20:23], s90 offen offset:3072 lds
    s_add_u32 s89, s89, 1
    s_and_b32 s89, s89, 7
    v_add_u32 v4, s7, v1
    v_and_b32 v4, 7, v4
    v_lshlrev_b32 v4, 7, v4
    v_and_b32 v5, 7, v0
    v_lshl_add_u32 v4, v5, 4, v4
    s_mov_b32 m0, 155648
    v_lshlrev_b32 v2, 4, v0
    buffer_load_dwordx4 v4, s[48:51], 0 offen lds
    v_mov_b32 v41, 0
    s_lshl_b32 s90, s84, 13
    s_add_u32 s90, s90, 32768
    v_add_u32 v4, s90, v2
    s_waitcnt vmcnt(17)
    s_barrier
    s_add_u32 m0, s87, 0
    s_lshl_b32 s90, s89, 7
    buffer_load_dwordx4 v8, s[16:19], s90 offen offset:0 lds
    buffer_load_dwordx4 v9, s[16:19], s90 offen offset:1024 lds
    buffer_load_dwordx4 v10, s[16:19], s90 offen offset:2048 lds
    buffer_load_dwordx4 v11, s[16:19], s90 offen offset:3072 lds
    s_mul_i32 s90, s89, 196608
    s_add_u32 m0, s87, 16384
    s_add_u32 s90, s90, s85
    buffer_load_dwordx4 v12, s[20:23], s90 offen offset:0 lds
    buffer_load_dwordx4 v13, s[20:23], s90 offen offset:1024 lds
    buffer_load_dwordx4 v14, s[20:23], s90 offen offset:2048 lds
    buffer_load_dwordx4 v15, s[20:23], s90 offen offset:3072 lds
    s_add_u32 s89, s89, 1
    s_and_b32 s89, s89, 7
    s_lshl_b32 s92, s4, 2
    s_add_u32 s92, s92, s84
    s_lshl_b32 s93, s5, 8
    s_add_u32 s93, s93, s92
    s_lshl_b32 s94, s93, 11
    s_add_u32 s94, s94, 0x400000
    s_lshl_b32 s95, s93, 10
    s_xor_b32 s60, s6, 1
    s_lshl_b32 s60, s60, 21
    s_add_u32 s95, s95, s60
    s_lshl_b32 s11, s5, 1
    s_add_u32 s11, s11, s6
    s_lshl_b32 s11, s11, 6
    s_add_u32 s11, s11, s92
    s_mul_i32 s11, s11, 128
    s_add_u32 s11, s11, 0x1080000
    v_and_b32 v40, 0x33, v0
    v_bfe_u32 v3, v0, 2, 1
    v_lshl_or_b32 v40, v3, 3, v40
    v_bfe_u32 v3, v0, 3, 1
    v_lshl_or_b32 v40, v3, 2, v40
    v_lshlrev_b32 v40, 4, v40
    s_mov_b32 s26, 0x20000
    s_mov_b32 s27, 0x20000
    s_cmp_eq_u32 s6, 0
    s_cbranch_scc1 Lsv_6
    v_and_b32 v40, 0x2f, v0
    v_lshlrev_b32 v40, 4, v40
    v_bfe_u32 v3, v0, 4, 1
    v_lshl_add_u32 v40, v3, 17, v40
    v_add_u32 v40, 1024, v40
    s_mov_b32 s26, 256
    s_mov_b32 s27, 0x3ff00
Lsv_6:
    s_waitcnt vmcnt(17)
    s_barrier
    s_mov_b64 exec, 1
    buffer_load_dwordx2 v[6:7], v41, s[52:55], 0 offen sc1
    s_mov_b64 exec, -1
    s_lshl_b32 s90, s84, 3
    s_lshr_b32 s91, 0xc121110, s90
    s_and_b32 s91, s91, 0xff
    s_lshl_b32 s91, s91, 13
    s_add_u32 s90, s7, s84
    s_and_b32 s90, s90, 7
    s_mul_i32 s90, s90, 196608
    s_mov_b32 m0, s91
    s_add_u32 s90, s90, s88
    buffer_load_dwordx4 v12, s[28:31], s90 offen offset:0 lds
    buffer_load_dwordx4 v13, s[28:31], s90 offen offset:1024 lds
    buffer_load_dwordx4 v14, s[28:31], s90 offen offset:2048 lds
    buffer_load_dwordx4 v15, s[28:31], s90 offen offset:3072 lds
    s_add_u32 m0, s91, 4096
    s_add_u32 s90, s90, 98304
    buffer_load_dwordx4 v12, s[28:31], s90 offen offset:0 lds
    buffer_load_dwordx4 v13, s[28:31], s90 offen offset:1024 lds
    buffer_load_dwordx4 v14, s[28:31], s90 offen offset:2048 lds
    buffer_load_dwordx4 v15, s[28:31], s90 offen offset:3072 lds
    s_waitcnt vmcnt(18)
    s_barrier
    s_lshl_b32 s90, s84, 3
    s_lshr_b32 s91, 0xb0f0e0d, s90
    s_and_b32 s91, s91, 0xff
    s_lshl_b32 s91, s91, 13
    s_add_u32 s90, s7, s84
    s_add_u32 s90, s90, 4
    s_and_b32 s90, s90, 7
    s_mul_i32 s90, s90, 196608
    s_mov_b32 m0, s91
    s_add_u32 s90, s90, s88
    buffer_load_dwordx4 v12, s[28:31], s90 offen offset:0 lds
    buffer_load_dwordx4 v13, s[28:31], s90 offen offset:1024 lds
    buffer_load_dwordx4 v14, s[28:31], s90 offen offset:2048 lds
    buffer_load_dwordx4 v15, s[28:31], s90 offen offset:3072 lds
    s_add_u32 m0, s91, 4096
    s_add_u32 s90, s90, 98304
    buffer_load_dwordx4 v12, s[28:31], s90 offen offset:0 lds
    buffer_load_dwordx4 v13, s[28:31], s90 offen offset:1024 lds
    buffer_load_dwordx4 v14, s[28:31], s90 offen offset:2048 lds
    buffer_load_dwordx4 v15, s[28:31], s90 offen offset:3072 lds
    s_waitcnt vmcnt(17)
    s_barrier
    v_lshrrev_b32 v5, 1, v0
    s_lshl_b32 s90, s9, 1
    v_add_u32 v5, s90, v5
    v_and_b32 v5, 15, v5
    v_lshl_add_u32 v5, v5, 2, s84
    v_and_b32 v42, 1, v0
    v_lshl_add_u32 v5, v42, 6, v5
    s_lshl_b32 s90, s84, 1
    s_lshl_b32 s91, s9, 3
    s_add_u32 s90, s90, s91
    v_add_u32 v42, s90, v42
    v_cmp_gt_u32 vcc, 6, v0
    v_mov_b32 v241, v2
    v_mov_b32 v242, v2
    v_cndmask_b32 v42, v42, v5, vcc
    v_mul_u32_u24 v42, 128, v42
    v_bfe_u32 v16, v0, 2, 2
    v_lshrrev_b32 v17, 5, v0
    v_lshl_add_u32 v16, v17, 2, v16
    v_lshlrev_b32 v16, 7, v16
    v_bfe_u32 v17, v0, 4, 1
    v_lshlrev_b32 v17, 1, v17
    v_bfe_u32 v18, v0, 1, 1
    v_or_b32 v17, v17, v18
    v_bfe_u32 v18, v0, 3, 1
    v_lshl_or_b32 v17, v18, 2, v17
    v_lshl_add_u32 v16, v17, 4, v16
    v_and_b32 v18, 1, v0
    v_lshl_add_u32 v16, v18, 3, v16
    s_lshr_b32 s58, s3, 1
    s_lshl_b32 s58, s58, 14
    v_add_u32 v16, s58, v16
    v_xor_b32 v17, 64, v16
    v_add_u32 v18, 0x10000, v16
CD_L15:
    v_add_u32 v19, 0x10000, v17
    v_and_b32 v3, 0x1b, v0
    v_cmp_eq_u32 vcc, 16, v3
    v_mov_b32 v3, 0x3f803f80
    s_mov_b32 s56, 0xffff
    s_mov_b32 s57, 0xffff
    v_cndmask_b32 v120, 0, v3, vcc
    v_cndmask_b32 v121, 0, v3, vcc
    v_mov_b64 v[122:123], v[120:121]
    v_mov_b64 v[124:125], v[120:121]
    v_mov_b64 v[126:127], v[120:121]
    v_mov_b64 v[128:129], v[120:121]
    v_mov_b64 v[130:131], v[120:121]
    v_mov_b64 v[132:133], v[120:121]
    v_mov_b64 v[134:135], v[120:121]
    v_mov_b32 v157, 0xff800000
    v_mov_b32 v152, 0xdddddddd
    v_mov_b32 v153, v2
    s_lshl_b32 s58, s3, 11
    s_add_u32 s58, s58, 131072
    v_add_u32 v154, s58, v2
    s_lshl_b32 s58, s3, 10
    s_add_u32 s58, s58, 81920
    v_add_u32 v156, s58, v2
    s_lshl_b32 s58, s9, 1
    v_add_u32 v158, s58, v0
    v_and_b32 v158, 15, v158
CD_L31:
    s_and_b32 s58, s3, 1
    s_lshl_b32 s58, s58, 6
    s_lshr_b32 s59, s3, 1
    s_add_u32 s58, s58, s59
    v_lshl_add_u32 v158, v158, 2, s58
    v_and_b32 v159, 1, v0
    s_lshl_b32 s58, s9, 3
    s_lshl_b32 s59, s3, 1
    s_add_u32 s58, s58, s59
    s_sub_i32 s58, s58, 8
    s_max_i32 s58, s58, 0
    s_add_u32 s58, s58, 1024
    v_add_u32 v159, s58, v159
    v_bfe_u32 v3, v0, 1, 1
    v_lshl_add_u32 v159, v3, 6, v159
    v_cmp_gt_u32 vcc, 16, v0
    v_and_b32 v3, 1, v0
    v_mul_u32_u24 v3, 1088, v3
    v_cndmask_b32 v158, v159, v158, vcc
    v_bfe_u32 v159, v0, 1, 1
    v_lshl_add_u32 v3, v159, 6, v3
    v_cmp_le_u32 vcc, 20, v0
    s_add_u32 s58, s10, 1024
    v_add_u32 v159, s58, v3
    s_nop 0
    v_cndmask_b32 v158, v158, v159, vcc
    v_mov_b64 v[160:161], 0
    v_mov_b64 v[162:163], 0
    v_mov_b64 v[164:165], 0
    v_mov_b64 v[166:167], 0
    v_mov_b64 v[168:169], 0
    v_mov_b64 v[170:171], 0
    v_mov_b64 v[172:173], 0
    v_mov_b64 v[174:175], 0
CD_L47:
    v_mov_b64 v[176:177], 0
    v_mov_b64 v[178:179], 0
    v_mov_b64 v[180:181], 0
    v_mov_b64 v[182:183], 0
    v_mov_b64 v[184:185], 0
    v_mov_b64 v[186:187], 0
    v_mov_b64 v[188:189], 0
    v_mov_b64 v[190:191], 0
    v_lshrrev_b32 v159, 3, v0
    v_bfe_u32 v3, v0, 4, 1
    v_lshlrev_b32 v3, 2, v3
    v_xor_b32 v3, v3, v0
    v_and_b32 v3, 7, v3
    v_lshlrev_b32 v3, 4, v3
    v_and_b32 v20, 15, v0
    v_lshrrev_b32 v21, 5, v0
    v_xor_b32 v20, v20, v21
    v_and_b32 v21, 31, v0
    v_lshlrev_b32 v21, 8, v21
    v_lshl_add_u32 v20, v20, 4, v21
    s_lshl_b32 s58, s3, 13
    s_add_u32 s58, s58, 0x10000
    v_add_u32 v20, s58, v20
    v_lshrrev_b32 v21, 3, v0
    s_lshl_b32 s58, s3, 3
    v_add_u32 v21, s58, v21
    v_and_b32 v22, 7, v0
    v_lshlrev_b32 v22, 1, v22
    v_xor_b32 v22, v22, v21
CD_L63:
    v_and_b32 v22, 15, v22
    v_lshlrev_b32 v22, 4, v22
    v_lshl_add_u32 v22, v21, 8, v22
    v_add_u32 v22, 0x10000, v22
    v_xor_b32 v23, 16, v22
    v_and_b32 v243, 7, v0
    v_lshlrev_b32 v243, 4, v243
    v_lshl_add_u32 v243, v21, 10, v243
    v_bfe_u32 v247, v0, 2, 1
    v_lshlrev_b32 v247, 7, v247
    v_and_or_b32 v247, v0, 3, v247
    v_lshlrev_b32 v247, 2, v247
    v_add_u32 v247, 131072, v247
    v_lshl_add_u32 v244, v159, 10, v3
    v_mul_u32_u24 v246, 128, v158
    v_mul_u32_u24 v245, 128, v0
    s_waitcnt vmcnt(8)
    s_setprio 3
    s_barrier
    ds_read_b128 v[24:27], v4 offset:0
    ds_read_b128 v[28:31], v4 offset:1024
    ds_read_b128 v[32:35], v4 offset:2048
    ds_read_b128 v[36:39], v4 offset:3072
    ds_read_b128 v[224:227], v4 offset:4096
    ds_read_b128 v[228:231], v4 offset:5120
    ds_read_b128 v[232:235], v4 offset:6144
    ds_read_b128 v[236:239], v4 offset:7168
    s_add_u32 s21, s94, 0x400000
    s_mov_b32 s19, s95
    s_waitcnt lgkmcnt(7)
    buffer_store_dwordx4 v[24:27], v40, s[32:35], s21 offen sc1
    s_add_u32 s21, s21, s26
    s_waitcnt lgkmcnt(6)
    buffer_store_dwordx4 v[28:31], v40, s[32:35], s21 offen sc1
    s_add_u32 s21, s21, s27
    s_waitcnt lgkmcnt(5)
    buffer_store_dwordx4 v[32:35], v40, s[32:35], s21 offen sc1
    s_add_u32 s21, s21, s26
    s_waitcnt lgkmcnt(4)
    buffer_store_dwordx4 v[36:39], v40, s[32:35], s21 offen sc1
    s_add_u32 s21, s21, s27
    s_mov_b32 s28, s19
    s_waitcnt lgkmcnt(0)
    s_cmp_lg_u32 s6, 0
    s_cbranch_scc1 Lq0_7
    buffer_store_dwordx4 v[224:227], v2, s[32:35], s19 offen sc1
    s_add_u32 s19, s19, 0x10000
    buffer_store_dwordx4 v[228:231], v2, s[32:35], s19 offen sc1
    s_add_u32 s19, s19, 0x10000
    buffer_store_dwordx4 v[232:235], v2, s[32:35], s19 offen sc1
    s_add_u32 s19, s19, 0x10000
    buffer_store_dwordx4 v[236:239], v2, s[32:35], s19 offen sc1
    s_add_u32 s19, s19, 0x10000
    s_waitcnt vmcnt(8)
    s_branch Lq1_8
Lq0_7:
    s_waitcnt vmcnt(4)
Lq1_8:
    s_barrier
    v_readfirstlane_b32 s12, v6
    v_readfirstlane_b32 s13, v7
    s_cmp_eq_u32 s12, 0
    s_cbranch_scc1 Lnp_9
Lnd_10:
    s_mov_b32 s29, 0x10000
    s_mov_b32 s30, 0x10000
    s_add_u32 s31, s11, 262144
    s_mov_b32 s25, s6
    s_mul_i32 s16, s5, 16384
    s_add_u32 s16, s16, 0x1080000
    s_lshl_b32 s18, s84, 11
    s_lshl_b32 s17, s8, 17
    s_add_u32 s17, s17, 0x800000
    s_add_u32 s17, s17, s18
    s_lshl_b32 s20, s9, 3
    s_lshl_b32 s19, s8, 6
    s_add_u32 s19, s19, s20
    s_lshl_b32 s19, s19, 10
    s_add_u32 s19, s19, s18
    s_add_u32 s19, s19, 0x200000
    v_lshrrev_b32 v3, 5, v0
    v_mul_u32_u24 v3, 40, v3
    v_sub_u32 v3, v0, v3
    v_cmp_le_i32 s[64:65], 0, v3
    v_cmp_le_i32 s[66:67], 1, v3
    v_cmp_le_i32 s[68:69], 2, v3
    v_cmp_le_i32 s[70:71], 3, v3
    v_cmp_le_i32 s[72:73], 4, v3
    v_cmp_le_i32 s[74:75], 5, v3
    v_cmp_le_i32 s[76:77], 6, v3
    v_cmp_le_i32 s[78:79], 7, v3
    v_cmp_le_i32 s[80:81], 16, v3
    v_cmp_le_i32 s[82:83], 17, v3
    v_cmp_le_i32 s[84:85], 18, v3
    v_cmp_le_i32 s[86:87], 19, v3
    v_cmp_le_i32 s[88:89], 20, v3
    v_cmp_le_i32 s[90:91], 21, v3
    v_cmp_le_i32 s[92:93], 22, v3
    v_cmp_le_i32 s[94:95], 23, v3
    v_cndmask_b32 v136, v157, 0, s[64:65]
    v_cndmask_b32 v137, v157, 0, s[66:67]
    v_cndmask_b32 v138, v157, 0, s[68:69]
    v_cndmask_b32 v139, v157, 0, s[70:71]
    v_cndmask_b32 v140, v157, 0, s[72:73]
    v_cndmask_b32 v141, v157, 0, s[74:75]
    v_cndmask_b32 v142, v157, 0, s[76:77]
    v_cndmask_b32 v143, v157, 0, s[78:79]
    v_cndmask_b32 v144, v157, 0, s[80:81]
    v_cndmask_b32 v145, v157, 0, s[82:83]
    v_cndmask_b32 v146, v157, 0, s[84:85]
    v_cndmask_b32 v147, v157, 0, s[86:87]
    v_cndmask_b32 v148, v157, 0, s[88:89]
    v_cndmask_b32 v149, v157, 0, s[90:91]
    v_cndmask_b32 v150, v157, 0, s[92:93]
    v_cndmask_b32 v151, v157, 0, s[94:95]
    s_add_u32 s21, s11, 393216
    s_add_u32 s22, s16, 393216
    s_waitcnt vmcnt(0)
    s_mov_b64 exec, 1
    buffer_store_dwordx2 v[6:7], v41, s[32:35], s21 offen
    s_mov_b64 exec, 0xff
    s_mov_b32 s62, 8
    buffer_load_dwordx2 v[24:25], v42, s[32:35], s22 offen sc1
    s_sleep 2
    buffer_load_dwordx2 v[26:27], v42, s[32:35], s22 offen sc1
    s_sleep 2
L_FL:
    buffer_load_dwordx2 v[28:29], v42, s[32:35], s22 offen sc1
    s_waitcnt vmcnt(2)
    v_cmp_ne_u64 vcc, s[12:13], v[24:25]
    s_cbranch_vccz L_FLD
    s_sleep 2
    buffer_load_dwordx2 v[24:25], v42, s[32:35], s22 offen sc1
    s_waitcnt vmcnt(2)
    v_cmp_ne_u64 vcc, s[12:13], v[26:27]
    s_cbranch_vccz L_FLD
    s_sleep 2
    buffer_load_dwordx2 v[26:27], v42, s[32:35], s22 offen sc1
    s_waitcnt vmcnt(2)
    v_cmp_ne_u64 vcc, s[12:13], v[28:29]
    s_cbranch_vccz L_FLD
    s_sleep 2
    s_sub_u32 s62, s62, 1
    s_cbranch_scc0 L_FL
    s_branch L_FG
L_FLD:
L_F0D:
    s_mov_b64 exec, -1
    s_add_u32 m0, s18, 81920
    s_lshl_b32 s22, s9, 14
    buffer_load_dwordx4 v2, s[32:35], s19 offen offset:0 sc1 lds
    buffer_load_dwordx4 v2, s[32:35], s19 offen offset:1024 sc1 lds
    s_add_u32 m0, s18, 0
    s_add_u32 s21, s22, s17
    buffer_load_dwordx4 v2, s[32:35], s21 offen offset:0 sc1 lds
    buffer_load_dwordx4 v2, s[32:35], s21 offen offset:1024 sc1 lds
    s_add_u32 s22, s22, 8192
    s_and_b32 s22, s22, 0x1ffff
    s_add_u32 m0, s18, 8192
    s_add_u32 s21, s22, s17
    buffer_load_dwordx4 v2, s[32:35], s21 offen offset:0 sc1 lds
    buffer_load_dwordx4 v2, s[32:35], s21 offen offset:1024 sc1 lds
    s_add_u32 s22, s22, 8192
    s_and_b32 s22, s22, 0x1ffff
    s_add_u32 m0, s18, 16384
    s_add_u32 s21, s22, s17
    buffer_load_dwordx4 v2, s[32:35], s21 offen offset:0 sc1 lds
    buffer_load_dwordx4 v2, s[32:35], s21 offen offset:1024 sc1 lds
    s_mov_b64 exec, 1
    buffer_store_dwordx2 v[6:7], v41, s[32:35], s11 offen sc1
    s_mov_b64 exec, -1
    s_setprio 0
    s_waitcnt vmcnt(1)
    s_branch L_P2
.p2align 12
L_AT:
CD_At:
    s_mov_b32 s28, s66
    s_mov_b32 s29, s67
    s_mov_b32 s30, 0x180000
    s_mov_b32 s31, 0x20000
    s_lshl_b32 s86, s4, 2
    s_add_u32 s86, s86, s3
    s_mul_i32 s86, s86, 24576
    s_lshl_b32 s87, s5, 7
    s_add_u32 s86, s86, s87
    s_lshl_b32 s87, s6, 10
    s_add_u32 s86, s86, s87
    v_mul_u32_u24 v24, 3072, v0
    s_mov_b64 exec, 0xff
    buffer_load_dword v248, v24, s[28:31], s86 offen offset:1024
    s_mov_b64 exec, -1
    s_barrier
    ds_read_b128 v[120:123], v4
    ds_read_b64_tr_b16 v[24:25], v10 offset:0
    ds_read_b64_tr_b16 v[26:27], v10 offset:512
    ds_read_b64_tr_b16 v[28:29], v11 offset:0
    ds_read_b64_tr_b16 v[30:31], v11 offset:512
    ds_read_b128 v[40:43], v16
    s_waitcnt lgkmcnt(3)
    v_mfma_f32_32x32x16_bf16 v[56:71], v[24:27], v[120:123], 0
    ds_read_b128 v[124:127], v5
    ds_read_b64_tr_b16 v[32:33], v10 offset:2048
    s_waitcnt lgkmcnt(3)
    v_mfma_f32_32x32x16_bf16 v[72:87], v[28:31], v[120:123], 0
    ds_read_b64_tr_b16 v[34:35], v10 offset:2560
    ds_read_b64_tr_b16 v[36:37], v11 offset:2048
    s_waitcnt lgkmcnt(4)
    v_mfma_f32_32x32x16_bf16 v[88:103], v[24:27], v[40:43], 0
    ds_read_b64_tr_b16 v[38:39], v11 offset:2560
    ds_read_b128 v[44:47], v17
    v_mfma_f32_32x32x16_bf16 v[104:119], v[28:31], v[40:43], 0
    s_mov_b32 s32, s82
    s_mov_b32 s33, s83
    s_mov_b32 s34, 0x1800000
    s_mov_b32 s35, 0x20000
CD_C0A0:
    s_waitcnt lgkmcnt(3)
    v_mfma_f32_32x32x16_bf16 v[56:71], v[32:35], v[124:127], v[56:71]
    ds_read_b128 v[128:131], v6
    ds_read_b64_tr_b16 v[24:25], v10 offset:4096
    s_waitcnt lgkmcnt(3)
    v_mfma_f32_32x32x16_bf16 v[72:87], v[36:39], v[124:127], v[72:87]
    ds_read_b64_tr_b16 v[26:27], v10 offset:4608
    ds_read_b64_tr_b16 v[28:29], v11 offset:4096
    s_waitcnt lgkmcnt(4)
    v_mfma_f32_32x32x16_bf16 v[88:103], v[32:35], v[44:47], v[88:103]
    ds_read_b64_tr_b16 v[30:31], v11 offset:4608
    ds_read_b128 v[40:43], v18
    v_mfma_f32_32x32x16_bf16 v[104:119], v[36:39], v[44:47], v[104:119]
    s_mov_b32 s52, s80
    s_mov_b32 s53, s81
    s_mov_b32 s54, 0x100
    s_mov_b32 s55, 0x20000
CD_C0A1:
    s_waitcnt lgkmcnt(3)
    v_mfma_f32_32x32x16_bf16 v[56:71], v[24:27], v[128:131], v[56:71]
    ds_read_b128 v[132:135], v7
    ds_read_b64_tr_b16 v[32:33], v10 offset:6144
    s_waitcnt lgkmcnt(3)
    v_mfma_f32_32x32x16_bf16 v[72:87], v[28:31], v[128:131], v[72:87]
    ds_read_b64_tr_b16 v[34:35], v10 offset:6656
    ds_read_b64_tr_b16 v[36:37], v11 offset:6144
    s_waitcnt lgkmcnt(4)
    v_mfma_f32_32x32x16_bf16 v[88:103], v[24:27], v[40:43], v[88:103]
    ds_read_b64_tr_b16 v[38:39], v11 offset:6656
    ds_read_b128 v[44:47], v19
    v_mfma_f32_32x32x16_bf16 v[104:119], v[28:31], v[40:43], v[104:119]
    s_mov_b32 s36, s78
    s_mov_b32 s37, s79
    s_mov_b32 s38, 0x200000
    s_mov_b32 s39, 0x20000
CD_C0A2:
    s_waitcnt lgkmcnt(3)
    v_mfma_f32_32x32x16_bf16 v[56:71], v[32:35], v[132:135], v[56:71]
    v_subrev_u32 v4, 32768, v4
    v_subrev_u32 v16, 32768, v16
    v_subrev_u32 v10, 32768, v10
    v_subrev_u32 v11, 32768, v11
    s_waitcnt lgkmcnt(0)
    v_mfma_f32_32x32x16_bf16 v[72:87], v[36:39], v[132:135], v[72:87]
    s_barrier
    ds_read_b128 v[136:139], v4
    ds_read_b64_tr_b16 v[24:25], v10 offset:0
    ds_read_b64_tr_b16 v[26:27], v10 offset:512
    v_mfma_f32_32x32x16_bf16 v[88:103], v[32:35], v[44:47], v[88:103]
    ds_read_b64_tr_b16 v[28:29], v11 offset:0
    ds_read_b64_tr_b16 v[30:31], v11 offset:512
    ds_read_b128 v[40:43], v16
    v_mfma_f32_32x32x16_bf16 v[104:119], v[36:39], v[44:47], v[104:119]
    v_subrev_u32 v5, 32768, v5
    v_subrev_u32 v6, 32768, v6
    v_subrev_u32 v7, 32768, v7
    v_subrev_u32 v17, 32768, v17
    v_subrev_u32 v18, 32768, v18
    v_subrev_u32 v19, 32768, v19
CD_C0A3:
    s_waitcnt lgkmcnt(3)
    v_mfma_f32_32x32x16_bf16 v[56:71], v[24:27], v[136:139], v[56:71]
    ds_read_b128 v[140:143], v5
    ds_read_b64_tr_b16 v[32:33], v10 offset:2048
    s_waitcnt lgkmcnt(3)
    v_mfma_f32_32x32x16_bf16 v[72:87], v[28:31], v[136:139], v[72:87]
    ds_read_b64_tr_b16 v[34:35], v10 offset:2560
    ds_read_b64_tr_b16 v[36:37], v11 offset:2048
    s_waitcnt lgkmcnt(4)
    v_mfma_f32_32x32x16_bf16 v[88:103], v[24:27], v[40:43], v[88:103]
    ds_read_b64_tr_b16 v[38:39], v11 offset:2560
    ds_read_b128 v[44:47], v17
    v_mfma_f32_32x32x16_bf16 v[104:119], v[28:31], v[40:43], v[104:119]
    s_mov_b32 s40, s68
    s_mov_b32 s41, s69
    s_mov_b32 s42, 0x80000
    s_mov_b32 s43, 0x20000
CD_C0A4:
    s_waitcnt lgkmcnt(3)
    v_mfma_f32_32x32x16_bf16 v[56:71], v[32:35], v[140:143], v[56:71]
    ds_read_b128 v[144:147], v6
    ds_read_b64_tr_b16 v[24:25], v10 offset:4096
    s_waitcnt lgkmcnt(3)
    v_mfma_f32_32x32x16_bf16 v[72:87], v[36:39], v[140:143], v[72:87]
    ds_read_b64_tr_b16 v[26:27], v10 offset:4608
    ds_read_b64_tr_b16 v[28:29], v11 offset:4096
    s_waitcnt lgkmcnt(4)
    v_mfma_f32_32x32x16_bf16 v[88:103], v[32:35], v[44:47], v[88:103]
    ds_read_b64_tr_b16 v[30:31], v11 offset:4608
    ds_read_b128 v[40:43], v18
    v_mfma_f32_32x32x16_bf16 v[104:119], v[36:39], v[44:47], v[104:119]
    s_mov_b32 s44, s74
    s_mov_b32 s45, s75
    s_mov_b32 s46, 0x80000
    s_mov_b32 s47, 0x20000
CD_C0A5:
    s_waitcnt lgkmcnt(3)
    v_mfma_f32_32x32x16_bf16 v[56:71], v[24:27], v[144:147], v[56:71]
    ds_read_b128 v[148:151], v7
    ds_read_b64_tr_b16 v[32:33], v10 offset:6144
    s_waitcnt lgkmcnt(3)
    v_mfma_f32_32x32x16_bf16 v[72:87], v[28:31], v[144:147], v[72:87]
    ds_read_b64_tr_b16 v[34:35], v10 offset:6656
    ds_read_b64_tr_b16 v[36:37], v11 offset:6144
    s_waitcnt lgkmcnt(4)
    v_mfma_f32_32x32x16_bf16 v[88:103], v[24:27], v[40:43], v[88:103]
    ds_read_b64_tr_b16 v[38:39], v11 offset:6656
    ds_read_b128 v[44:47], v19
    v_mfma_f32_32x32x16_bf16 v[104:119], v[28:31], v[40:43], v[104:119]
    s_lshl_b32 s8, s5, 2
    s_bfe_u32 s60, s2, 0x20003
    s_add_u32 s8, s8, s60
    s_lshr_b32 s9, s2, 5
    s_lshl_b32 s10, s9, 3
    s_add_u32 s10, s10, s3
CD_C0A6:
    s_waitcnt lgkmcnt(3)
    v_mfma_f32_32x32x16_bf16 v[56:71], v[32:35], v[148:151], v[56:71]
    v_subrev_u32 v4, 32768, v4
    v_subrev_u32 v16, 32768, v16
    v_subrev_u32 v10, 32768, v10
    v_subrev_u32 v11, 32768, v11
    s_waitcnt lgkmcnt(0)
    v_mfma_f32_32x32x16_bf16 v[72:87], v[36:39], v[148:151], v[72:87]
    s_barrier
    ds_read_b128 v[152:155], v4
    ds_read_b64_tr_b16 v[24:25], v10 offset:0
    ds_read_b64_tr_b16 v[26:27], v10 offset:512
    v_mfma_f32_32x32x16_bf16 v[88:103], v[32:35], v[44:47], v[88:103]
    ds_read_b64_tr_b16 v[28:29], v11 offset:0
    ds_read_b64_tr_b16 v[30:31], v11 offset:512
    ds_read_b128 v[40:43], v16
    v_mfma_f32_32x32x16_bf16 v[104:119], v[36:39], v[44:47], v[104:119]
    v_subrev_u32 v5, 32768, v5
    v_subrev_u32 v6, 32768, v6
    v_subrev_u32 v7, 32768, v7
    v_subrev_u32 v17, 32768, v17
    v_subrev_u32 v18, 32768, v18
    v_subrev_u32 v19, 32768, v19
CD_C0A7:
    s_waitcnt lgkmcnt(3)
    v_mfma_f32_32x32x16_bf16 v[56:71], v[24:27], v[152:155], v[56:71]
    ds_read_b128 v[156:159], v5
    ds_read_b64_tr_b16 v[32:33], v10 offset:2048
    s_waitcnt lgkmcnt(3)
    v_mfma_f32_32x32x16_bf16 v[72:87], v[28:31], v[152:155], v[72:87]
    ds_read_b64_tr_b16 v[34:35], v10 offset:2560
    ds_read_b64_tr_b16 v[36:37], v11 offset:2048
    s_waitcnt lgkmcnt(4)
    v_mfma_f32_32x32x16_bf16 v[88:103], v[24:27], v[40:43], v[88:103]
    ds_read_b64_tr_b16 v[38:39], v11 offset:2560
    ds_read_b128 v[44:47], v17
    v_mfma_f32_32x32x16_bf16 v[104:119], v[28:31], v[40:43], v[104:119]
    v_lshlrev_b32 v2, 4, v0
CD_C0A8:
    s_waitcnt lgkmcnt(3)
    v_mfma_f32_32x32x16_bf16 v[56:71], v[32:35], v[156:159], v[56:71]
    ds_read_b128 v[160:163], v6
    ds_read_b64_tr_b16 v[24:25], v10 offset:4096
    s_waitcnt lgkmcnt(3)
    v_mfma_f32_32x32x16_bf16 v[72:87], v[36:39], v[156:159], v[72:87]
    ds_read_b64_tr_b16 v[26:27], v10 offset:4608
    ds_read_b64_tr_b16 v[28:29], v11 offset:4096
    s_waitcnt lgkmcnt(4)
    v_mfma_f32_32x32x16_bf16 v[88:103], v[32:35], v[44:47], v[88:103]
    ds_read_b64_tr_b16 v[30:31], v11 offset:4608
    ds_read_b128 v[40:43], v18
    v_mfma_f32_32x32x16_bf16 v[104:119], v[36:39], v[44:47], v[104:119]
    s_lshl_b32 s16, s4, 2
    s_add_u32 s16, s16, s15
    s_lshl_b32 s17, s5, 8
    s_add_u32 s17, s17, s16
CD_C0A9:
    s_waitcnt lgkmcnt(3)
    v_mfma_f32_32x32x16_bf16 v[56:71], v[24:27], v[160:163], v[56:71]
    ds_read_b128 v[164:167], v7
    ds_read_b64_tr_b16 v[32:33], v10 offset:6144
    s_waitcnt lgkmcnt(3)
    v_mfma_f32_32x32x16_bf16 v[72:87], v[28:31], v[160:163], v[72:87]
    ds_read_b64_tr_b16 v[34:35], v10 offset:6656
    ds_read_b64_tr_b16 v[36:37], v11 offset:6144
    s_waitcnt lgkmcnt(4)
    v_mfma_f32_32x32x16_bf16 v[88:103], v[24:27], v[40:43], v[88:103]
    ds_read_b64_tr_b16 v[38:39], v11 offset:6656
    ds_read_b128 v[44:47], v19
    v_mfma_f32_32x32x16_bf16 v[104:119], v[28:31], v[40:43], v[104:119]
    s_lshl_b32 s18, s17, 11
    s_add_u32 s18, s18, 0x400000
    s_lshl_b32 s19, s17, 10
    s_xor_b32 s20, s6, 1
CD_C0A10:
    s_waitcnt lgkmcnt(3)
    v_mfma_f32_32x32x16_bf16 v[56:71], v[32:35], v[164:167], v[56:71]
    v_subrev_u32 v4, 32768, v4
    v_subrev_u32 v16, 32768, v16
    v_subrev_u32 v10, 32768, v10
    v_subrev_u32 v11, 32768, v11
    s_waitcnt lgkmcnt(0)
    v_mfma_f32_32x32x16_bf16 v[72:87], v[36:39], v[164:167], v[72:87]
    s_barrier
    ds_read_b128 v[168:171], v4
    ds_read_b64_tr_b16 v[24:25], v10 offset:0
    ds_read_b64_tr_b16 v[26:27], v10 offset:512
    v_mfma_f32_32x32x16_bf16 v[88:103], v[32:35], v[44:47], v[88:103]
    ds_read_b64_tr_b16 v[28:29], v11 offset:0
    ds_read_b64_tr_b16 v[30:31], v11 offset:512
    ds_read_b128 v[40:43], v16
    v_mfma_f32_32x32x16_bf16 v[104:119], v[36:39], v[44:47], v[104:119]
    v_subrev_u32 v5, 32768, v5
    v_subrev_u32 v6, 32768, v6
    v_subrev_u32 v7, 32768, v7
    v_subrev_u32 v17, 32768, v17
    v_subrev_u32 v18, 32768, v18
    v_subrev_u32 v19, 32768, v19
CD_C0A11:
    s_waitcnt lgkmcnt(3)
    v_mfma_f32_32x32x16_bf16 v[56:71], v[24:27], v[168:171], v[56:71]
    ds_read_b128 v[172:175], v5
    ds_read_b64_tr_b16 v[32:33], v10 offset:2048
    s_waitcnt lgkmcnt(3)
    v_mfma_f32_32x32x16_bf16 v[72:87], v[28:31], v[168:171], v[72:87]
    ds_read_b64_tr_b16 v[34:35], v10 offset:2560
    ds_read_b64_tr_b16 v[36:37], v11 offset:2048
    s_waitcnt lgkmcnt(4)
    v_mfma_f32_32x32x16_bf16 v[88:103], v[24:27], v[40:43], v[88:103]
    ds_read_b64_tr_b16 v[38:39], v11 offset:2560
    ds_read_b128 v[44:47], v17
    v_mfma_f32_32x32x16_bf16 v[104:119], v[28:31], v[40:43], v[104:119]
    s_lshl_b32 s20, s20, 21
    s_add_u32 s19, s19, s20
    s_lshl_b32 s11, s5, 1
    s_add_u32 s11, s11, s6
CD_C0A12:
    s_waitcnt lgkmcnt(3)
    v_mfma_f32_32x32x16_bf16 v[56:71], v[32:35], v[172:175], v[56:71]
    ds_read_b128 v[176:179], v6
    ds_read_b64_tr_b16 v[24:25], v10 offset:4096
    s_waitcnt lgkmcnt(3)
    v_mfma_f32_32x32x16_bf16 v[72:87], v[36:39], v[172:175], v[72:87]
    ds_read_b64_tr_b16 v[26:27], v10 offset:4608
    ds_read_b64_tr_b16 v[28:29], v11 offset:4096
    s_waitcnt lgkmcnt(4)
    v_mfma_f32_32x32x16_bf16 v[88:103], v[32:35], v[44:47], v[88:103]
    ds_read_b64_tr_b16 v[30:31], v11 offset:4608
    ds_read_b128 v[40:43], v18
    v_mfma_f32_32x32x16_bf16 v[104:119], v[36:39], v[44:47], v[104:119]
    s_lshl_b32 s11, s11, 6
    s_add_u32 s11, s11, s16
    s_mul_i32 s11, s11, 128
    s_add_u32 s11, s11, 0x1080000
CD_C0A13:
    s_waitcnt lgkmcnt(3)
    v_mfma_f32_32x32x16_bf16 v[56:71], v[24:27], v[176:179], v[56:71]
    ds_read_b128 v[180:183], v7
    ds_read_b64_tr_b16 v[32:33], v10 offset:6144
    s_waitcnt lgkmcnt(3)
    v_mfma_f32_32x32x16_bf16 v[72:87], v[28:31], v[176:179], v[72:87]
    ds_read_b64_tr_b16 v[34:35], v10 offset:6656
    ds_read_b64_tr_b16 v[36:37], v11 offset:6144
    s_waitcnt lgkmcnt(4)
    v_mfma_f32_32x32x16_bf16 v[88:103], v[24:27], v[40:43], v[88:103]
    ds_read_b64_tr_b16 v[38:39], v11 offset:6656
    ds_read_b128 v[44:47], v19
    v_mfma_f32_32x32x16_bf16 v[104:119], v[28:31], v[40:43], v[104:119]
    v_and_b32 v12, 0x33, v0
    v_bfe_u32 v3, v0, 2, 1
    v_lshl_or_b32 v12, v3, 3, v12
    v_bfe_u32 v3, v0, 3, 1
    v_lshl_or_b32 v12, v3, 2, v12
    v_lshlrev_b32 v12, 4, v12
    s_mov_b32 s26, 0x20000
    s_mov_b32 s27, 0x20000
    s_cmp_eq_u32 s6, 0
    s_cbranch_scc1 Lsv_11
    v_and_b32 v12, 0x2f, v0
    v_lshlrev_b32 v12, 4, v12
    v_bfe_u32 v3, v0, 4, 1
    v_lshl_add_u32 v12, v3, 17, v12
    v_add_u32 v12, 1024, v12
    s_mov_b32 s26, 256
    s_mov_b32 s27, 0x3ff00
Lsv_11:
CD_C0A14:
    s_waitcnt lgkmcnt(3)
    v_mfma_f32_32x32x16_bf16 v[56:71], v[32:35], v[180:183], v[56:71]
    v_add_u32 v4, 98304, v4
    v_add_u32 v16, 98304, v16
    v_add_u32 v10, 98304, v10
    v_add_u32 v11, 98304, v11
    s_waitcnt lgkmcnt(0)
    v_mfma_f32_32x32x16_bf16 v[72:87], v[36:39], v[180:183], v[72:87]
    s_barrier
    ds_read_b128 v[184:187], v4
    ds_read_b64_tr_b16 v[24:25], v10 offset:0
    ds_read_b64_tr_b16 v[26:27], v10 offset:512
    v_mfma_f32_32x32x16_bf16 v[88:103], v[32:35], v[44:47], v[88:103]
    ds_read_b64_tr_b16 v[28:29], v11 offset:0
    ds_read_b64_tr_b16 v[30:31], v11 offset:512
    ds_read_b128 v[40:43], v16
    v_mfma_f32_32x32x16_bf16 v[104:119], v[36:39], v[44:47], v[104:119]
    v_add_u32 v5, 98304, v5
    v_add_u32 v6, 98304, v6
    v_add_u32 v7, 98304, v7
    v_add_u32 v17, 98304, v17
    v_add_u32 v18, 98304, v18
    v_add_u32 v19, 98304, v19
CD_C0A15:
    s_waitcnt lgkmcnt(3)
    v_mfma_f32_32x32x16_bf16 v[56:71], v[24:27], v[184:187], v[56:71]
    ds_read_b128 v[188:191], v5
    ds_read_b64_tr_b16 v[32:33], v10 offset:2048
    s_waitcnt lgkmcnt(3)
    v_mfma_f32_32x32x16_bf16 v[72:87], v[28:31], v[184:187], v[72:87]
    ds_read_b64_tr_b16 v[34:35], v10 offset:2560
    ds_read_b64_tr_b16 v[36:37], v11 offset:2048
    s_waitcnt lgkmcnt(4)
    v_mfma_f32_32x32x16_bf16 v[88:103], v[24:27], v[40:43], v[88:103]
    ds_read_b64_tr_b16 v[38:39], v11 offset:2560
    ds_read_b128 v[44:47], v17
    v_mfma_f32_32x32x16_bf16 v[104:119], v[28:31], v[40:43], v[104:119]
    s_lshl_b32 s24, s5, 13
    s_lshl_b32 s25, s16, 7
    s_add_u32 s24, s24, s25
    s_lshl_b32 s25, s6, 16
    s_add_u32 s24, s24, s25
    s_add_u32 s24, s24, 0x1000000
CD_C0A16:
    s_waitcnt lgkmcnt(3)
    v_mfma_f32_32x32x16_bf16 v[56:71], v[32:35], v[188:191], v[56:71]
    ds_read_b128 v[192:195], v6
    ds_read_b64_tr_b16 v[24:25], v10 offset:4096
    s_waitcnt lgkmcnt(3)
    v_mfma_f32_32x32x16_bf16 v[72:87], v[36:39], v[188:191], v[72:87]
    ds_read_b64_tr_b16 v[26:27], v10 offset:4608
    ds_read_b64_tr_b16 v[28:29], v11 offset:4096
    s_waitcnt lgkmcnt(4)
    v_mfma_f32_32x32x16_bf16 v[88:103], v[32:35], v[44:47], v[88:103]
    ds_read_b64_tr_b16 v[30:31], v11 offset:4608
    ds_read_b128 v[40:43], v18
    v_mfma_f32_32x32x16_bf16 v[104:119], v[36:39], v[44:47], v[104:119]
    v_add_u32 v14, 155648, v14
    s_mov_b32 s22, 0x3eb8aa3b
    s_mov_b32 s23, 0x3eb8aa3b
CD_C0A17:
    s_waitcnt lgkmcnt(3)
    v_mfma_f32_32x32x16_bf16 v[56:71], v[24:27], v[192:195], v[56:71]
    ds_read_b128 v[196:199], v7
    ds_read_b64_tr_b16 v[32:33], v10 offset:6144
    s_waitcnt lgkmcnt(3)
    v_mfma_f32_32x32x16_bf16 v[72:87], v[28:31], v[192:195], v[72:87]
    ds_read_b64_tr_b16 v[34:35], v10 offset:6656
    ds_read_b64_tr_b16 v[36:37], v11 offset:6144
    s_waitcnt lgkmcnt(4)
    v_mfma_f32_32x32x16_bf16 v[88:103], v[24:27], v[40:43], v[88:103]
    ds_read_b64_tr_b16 v[38:39], v11 offset:6656
    ds_read_b128 v[44:47], v19
    v_mfma_f32_32x32x16_bf16 v[104:119], v[28:31], v[40:43], v[104:119]
    s_lshl_b32 s21, s15, 1
    s_add_u32 s21, s21, s61
    s_lshl_b32 s21, s21, 12
    s_add_u32 s21, s21, 32768
    v_add_u32 v15, s21, v2
CD_C0A18:
    s_waitcnt lgkmcnt(3)
    v_mfma_f32_32x32x16_bf16 v[56:71], v[32:35], v[196:199], v[56:71]
    v_subrev_u32 v4, 32768, v4
    v_subrev_u32 v16, 32768, v16
    v_subrev_u32 v10, 32768, v10
    v_subrev_u32 v11, 32768, v11
    s_waitcnt lgkmcnt(0)
    v_mfma_f32_32x32x16_bf16 v[72:87], v[36:39], v[196:199], v[72:87]
    s_barrier
    ds_read_b128 v[200:203], v4
    ds_read_b64_tr_b16 v[24:25], v10 offset:0
    ds_read_b64_tr_b16 v[26:27], v10 offset:512
    v_mfma_f32_32x32x16_bf16 v[88:103], v[32:35], v[44:47], v[88:103]
    ds_read_b64_tr_b16 v[28:29], v11 offset:0
    ds_read_b64_tr_b16 v[30:31], v11 offset:512
    ds_read_b128 v[40:43], v16
    v_mfma_f32_32x32x16_bf16 v[104:119], v[36:39], v[44:47], v[104:119]
    v_subrev_u32 v5, 32768, v5
    v_subrev_u32 v6, 32768, v6
    v_subrev_u32 v7, 32768, v7
    v_subrev_u32 v17, 32768, v17
    v_subrev_u32 v18, 32768, v18
    v_subrev_u32 v19, 32768, v19
CD_C0A19:
    s_waitcnt lgkmcnt(3)
    v_mfma_f32_32x32x16_bf16 v[56:71], v[24:27], v[200:203], v[56:71]
    ds_read_b128 v[204:207], v5
    ds_read_b64_tr_b16 v[32:33], v10 offset:2048
    s_waitcnt lgkmcnt(3)
    v_mfma_f32_32x32x16_bf16 v[72:87], v[28:31], v[200:203], v[72:87]
    ds_read_b64_tr_b16 v[34:35], v10 offset:2560
    ds_read_b64_tr_b16 v[36:37], v11 offset:2048
    s_waitcnt lgkmcnt(4)
    v_mfma_f32_32x32x16_bf16 v[88:103], v[24:27], v[40:43], v[88:103]
    ds_read_b64_tr_b16 v[38:39], v11 offset:2560
    ds_read_b128 v[44:47], v17
    v_mfma_f32_32x32x16_bf16 v[104:119], v[28:31], v[40:43], v[104:119]
CD_C0A20:
    s_waitcnt lgkmcnt(3)
    v_mfma_f32_32x32x16_bf16 v[56:71], v[32:35], v[204:207], v[56:71]
    ds_read_b128 v[208:211], v6
    ds_read_b64_tr_b16 v[24:25], v10 offset:4096
    s_waitcnt lgkmcnt(3)
    v_mfma_f32_32x32x16_bf16 v[72:87], v[36:39], v[204:207], v[72:87]
    ds_read_b64_tr_b16 v[26:27], v10 offset:4608
    ds_read_b64_tr_b16 v[28:29], v11 offset:4096
    s_waitcnt lgkmcnt(4)
    v_mfma_f32_32x32x16_bf16 v[88:103], v[32:35], v[44:47], v[88:103]
    ds_read_b64_tr_b16 v[30:31], v11 offset:4608
    ds_read_b128 v[40:43], v18
    v_mfma_f32_32x32x16_bf16 v[104:119], v[36:39], v[44:47], v[104:119]
CD_C0A21:
    s_waitcnt lgkmcnt(3)
    v_mfma_f32_32x32x16_bf16 v[56:71], v[24:27], v[208:211], v[56:71]
    ds_read_b128 v[212:215], v7
    ds_read_b64_tr_b16 v[32:33], v10 offset:6144
    s_waitcnt lgkmcnt(3)
    v_mfma_f32_32x32x16_bf16 v[72:87], v[28:31], v[208:211], v[72:87]
    ds_read_b64_tr_b16 v[34:35], v10 offset:6656
    ds_read_b64_tr_b16 v[36:37], v11 offset:6144
    s_waitcnt lgkmcnt(4)
    v_mfma_f32_32x32x16_bf16 v[88:103], v[24:27], v[40:43], v[88:103]
    ds_read_b64_tr_b16 v[38:39], v11 offset:6656
    ds_read_b128 v[44:47], v19
    v_mfma_f32_32x32x16_bf16 v[104:119], v[28:31], v[40:43], v[104:119]
CD_C0A22:
    s_waitcnt lgkmcnt(3)
    v_mfma_f32_32x32x16_bf16 v[56:71], v[32:35], v[212:215], v[56:71]
    v_subrev_u32 v4, 32768, v4
    v_subrev_u32 v16, 32768, v16
    v_subrev_u32 v10, 32768, v10
    v_subrev_u32 v11, 32768, v11
    s_waitcnt lgkmcnt(0)
    v_mfma_f32_32x32x16_bf16 v[72:87], v[36:39], v[212:215], v[72:87]
    s_barrier
    ds_read_b128 v[216:219], v4
    ds_read_b64_tr_b16 v[24:25], v10 offset:0
    ds_read_b64_tr_b16 v[26:27], v10 offset:512
    v_mfma_f32_32x32x16_bf16 v[88:103], v[32:35], v[44:47], v[88:103]
    ds_read_b64_tr_b16 v[28:29], v11 offset:0
    ds_read_b64_tr_b16 v[30:31], v11 offset:512
    ds_read_b128 v[40:43], v16
    v_mfma_f32_32x32x16_bf16 v[104:119], v[36:39], v[44:47], v[104:119]
    v_subrev_u32 v5, 32768, v5
    v_subrev_u32 v6, 32768, v6
    v_subrev_u32 v7, 32768, v7
    v_subrev_u32 v17, 32768, v17
    v_subrev_u32 v18, 32768, v18
    v_subrev_u32 v19, 32768, v19
CD_C0A23:
    s_waitcnt lgkmcnt(3)
    v_mfma_f32_32x32x16_bf16 v[56:71], v[24:27], v[216:219], v[56:71]
    ds_read_b128 v[220:223], v5
    ds_read_b64_tr_b16 v[32:33], v10 offset:2048
    s_waitcnt lgkmcnt(3)
    v_mfma_f32_32x32x16_bf16 v[72:87], v[28:31], v[216:219], v[72:87]
    ds_read_b64_tr_b16 v[34:35], v10 offset:2560
    ds_read_b64_tr_b16 v[36:37], v11 offset:2048
    s_waitcnt lgkmcnt(4)
    v_mfma_f32_32x32x16_bf16 v[88:103], v[24:27], v[40:43], v[88:103]
    ds_read_b64_tr_b16 v[38:39], v11 offset:2560
    ds_read_b128 v[44:47], v17
    v_mfma_f32_32x32x16_bf16 v[104:119], v[28:31], v[40:43], v[104:119]
CD_C0A24:
    s_waitcnt lgkmcnt(3)
    v_mfma_f32_32x32x16_bf16 v[56:71], v[32:35], v[220:223], v[56:71]
    ds_read_b128 v[224:227], v6
    ds_read_b64_tr_b16 v[24:25], v10 offset:4096
    s_waitcnt lgkmcnt(3)
    v_mfma_f32_32x32x16_bf16 v[72:87], v[36:39], v[220:223], v[72:87]
    ds_read_b64_tr_b16 v[26:27], v10 offset:4608
    ds_read_b64_tr_b16 v[28:29], v11 offset:4096
    s_waitcnt lgkmcnt(4)
    v_mfma_f32_32x32x16_bf16 v[88:103], v[32:35], v[44:47], v[88:103]
    ds_read_b64_tr_b16 v[30:31], v11 offset:4608
    ds_read_b128 v[40:43], v18
    v_mfma_f32_32x32x16_bf16 v[104:119], v[36:39], v[44:47], v[104:119]
CD_C0A25:
    s_waitcnt lgkmcnt(3)
    v_mfma_f32_32x32x16_bf16 v[56:71], v[24:27], v[224:227], v[56:71]
    ds_read_b128 v[228:231], v7
    ds_read_b64_tr_b16 v[32:33], v10 offset:6144
    s_waitcnt lgkmcnt(3)
    v_mfma_f32_32x32x16_bf16 v[72:87], v[28:31], v[224:227], v[72:87]
    ds_read_b64_tr_b16 v[34:35], v10 offset:6656
    ds_read_b64_tr_b16 v[36:37], v11 offset:6144
    s_waitcnt lgkmcnt(4)
    v_mfma_f32_32x32x16_bf16 v[88:103], v[24:27], v[40:43], v[88:103]
    ds_read_b64_tr_b16 v[38:39], v11 offset:6656
    ds_read_b128 v[44:47], v19
    v_mfma_f32_32x32x16_bf16 v[104:119], v[28:31], v[40:43], v[104:119]
CD_C0A26:
    s_waitcnt lgkmcnt(3)
    v_mfma_f32_32x32x16_bf16 v[56:71], v[32:35], v[228:231], v[56:71]
    v_subrev_u32 v4, 32768, v4
    v_subrev_u32 v16, 32768, v16
    v_subrev_u32 v10, 32768, v10
    v_subrev_u32 v11, 32768, v11
    s_waitcnt lgkmcnt(0)
    v_mfma_f32_32x32x16_bf16 v[72:87], v[36:39], v[228:231], v[72:87]
    s_barrier
    ds_read_b128 v[232:235], v4
    ds_read_b64_tr_b16 v[24:25], v10 offset:0
    ds_read_b64_tr_b16 v[26:27], v10 offset:512
    v_mfma_f32_32x32x16_bf16 v[88:103], v[32:35], v[44:47], v[88:103]
    ds_read_b64_tr_b16 v[28:29], v11 offset:0
    ds_read_b64_tr_b16 v[30:31], v11 offset:512
    ds_read_b128 v[40:43], v16
    v_mfma_f32_32x32x16_bf16 v[104:119], v[36:39], v[44:47], v[104:119]
    v_subrev_u32 v5, 32768, v5
    v_subrev_u32 v6, 32768, v6
    v_subrev_u32 v7, 32768, v7
    v_subrev_u32 v17, 32768, v17
    v_subrev_u32 v18, 32768, v18
    v_subrev_u32 v19, 32768, v19
CD_C0A27:
    s_waitcnt lgkmcnt(3)
    v_mfma_f32_32x32x16_bf16 v[56:71], v[24:27], v[232:235], v[56:71]
    ds_read_b128 v[236:239], v5
    ds_read_b64_tr_b16 v[32:33], v10 offset:2048
    s_waitcnt lgkmcnt(3)
    v_mfma_f32_32x32x16_bf16 v[72:87], v[28:31], v[232:235], v[72:87]
    ds_read_b64_tr_b16 v[34:35], v10 offset:2560
    ds_read_b64_tr_b16 v[36:37], v11 offset:2048
    s_waitcnt lgkmcnt(4)
    v_mfma_f32_32x32x16_bf16 v[88:103], v[24:27], v[40:43], v[88:103]
    ds_read_b64_tr_b16 v[38:39], v11 offset:2560
    ds_read_b128 v[44:47], v17
    v_mfma_f32_32x32x16_bf16 v[104:119], v[28:31], v[40:43], v[104:119]
CD_C0A28:
    s_waitcnt lgkmcnt(3)
    v_mfma_f32_32x32x16_bf16 v[56:71], v[32:35], v[236:239], v[56:71]
    ds_read_b128 v[240:243], v6
    ds_read_b64_tr_b16 v[24:25], v10 offset:4096
    s_waitcnt lgkmcnt(3)
    v_mfma_f32_32x32x16_bf16 v[72:87], v[36:39], v[236:239], v[72:87]
    ds_read_b64_tr_b16 v[26:27], v10 offset:4608
    ds_read_b64_tr_b16 v[28:29], v11 offset:4096
    s_waitcnt lgkmcnt(4)
    v_mfma_f32_32x32x16_bf16 v[88:103], v[32:35], v[44:47], v[88:103]
    ds_read_b64_tr_b16 v[30:31], v11 offset:4608
    ds_read_b128 v[40:43], v18
    v_mfma_f32_32x32x16_bf16 v[104:119], v[36:39], v[44:47], v[104:119]
CD_C0A29:
    s_waitcnt lgkmcnt(3)
    v_mfma_f32_32x32x16_bf16 v[56:71], v[24:27], v[240:243], v[56:71]
    ds_read_b128 v[244:247], v7
    ds_read_b64_tr_b16 v[32:33], v10 offset:6144
    s_waitcnt lgkmcnt(3)
    v_mfma_f32_32x32x16_bf16 v[72:87], v[28:31], v[240:243], v[72:87]
    ds_read_b64_tr_b16 v[34:35], v10 offset:6656
    ds_read_b64_tr_b16 v[36:37], v11 offset:6144
    s_waitcnt lgkmcnt(4)
    v_mfma_f32_32x32x16_bf16 v[88:103], v[24:27], v[40:43], v[88:103]
    ds_read_b64_tr_b16 v[38:39], v11 offset:6656
    ds_read_b128 v[44:47], v19
    v_mfma_f32_32x32x16_bf16 v[104:119], v[28:31], v[40:43], v[104:119]
CD_C0A30:
    s_waitcnt lgkmcnt(3)
    v_mfma_f32_32x32x16_bf16 v[56:71], v[32:35], v[244:247], v[56:71]
    s_waitcnt lgkmcnt(1)
    v_mfma_f32_32x32x16_bf16 v[72:87], v[36:39], v[244:247], v[72:87]
    s_waitcnt lgkmcnt(0)
    v_mfma_f32_32x32x16_bf16 v[88:103], v[32:35], v[44:47], v[88:103]
    v_mfma_f32_32x32x16_bf16 v[104:119], v[36:39], v[44:47], v[104:119]
CD_C0A31:
    s_branch SK_C0A31
.p2align 12
PG_C0A31:
    s_setpc_b64 s[100:101]
SK_C0A31:
    v_xor_b32 v16, 0x2000, v15
    s_nop 7
    s_cmp_eq_u32 s61, 0
    s_cbranch_scc1 Lns_12
    v_pk_mul_f32 v[56:57], v[56:57], s[22:23]
    v_pk_mul_f32 v[58:59], v[58:59], s[22:23]
    v_pk_mul_f32 v[60:61], v[60:61], s[22:23]
    v_pk_mul_f32 v[62:63], v[62:63], s[22:23]
    v_pk_mul_f32 v[64:65], v[64:65], s[22:23]
    v_pk_mul_f32 v[66:67], v[66:67], s[22:23]
    v_pk_mul_f32 v[68:69], v[68:69], s[22:23]
    v_pk_mul_f32 v[70:71], v[70:71], s[22:23]
    v_pk_mul_f32 v[72:73], v[72:73], s[22:23]
    v_pk_mul_f32 v[74:75], v[74:75], s[22:23]
    v_pk_mul_f32 v[76:77], v[76:77], s[22:23]
    v_pk_mul_f32 v[78:79], v[78:79], s[22:23]
    v_pk_mul_f32 v[80:81], v[80:81], s[22:23]
    v_pk_mul_f32 v[82:83], v[82:83], s[22:23]
    v_pk_mul_f32 v[84:85], v[84:85], s[22:23]
    v_pk_mul_f32 v[86:87], v[86:87], s[22:23]
    v_pk_mul_f32 v[88:89], v[88:89], s[22:23]
    v_pk_mul_f32 v[90:91], v[90:91], s[22:23]
    v_pk_mul_f32 v[92:93], v[92:93], s[22:23]
    v_pk_mul_f32 v[94:95], v[94:95], s[22:23]
    v_pk_mul_f32 v[96:97], v[96:97], s[22:23]
    v_pk_mul_f32 v[98:99], v[98:99], s[22:23]
    v_pk_mul_f32 v[100:101], v[100:101], s[22:23]
    v_pk_mul_f32 v[102:103], v[102:103], s[22:23]
    v_pk_mul_f32 v[104:105], v[104:105], s[22:23]
    v_pk_mul_f32 v[106:107], v[106:107], s[22:23]
    v_pk_mul_f32 v[108:109], v[108:109], s[22:23]
    v_pk_mul_f32 v[110:111], v[110:111], s[22:23]
    v_pk_mul_f32 v[112:113], v[112:113], s[22:23]
    v_pk_mul_f32 v[114:115], v[114:115], s[22:23]
    v_pk_mul_f32 v[116:117], v[116:117], s[22:23]
    v_pk_mul_f32 v[118:119], v[118:119], s[22:23]
Lns_12:
    v_cvt_pk_bf16_f32 v56, v56, v57
    v_cvt_pk_bf16_f32 v57, v58, v59
    v_cvt_pk_bf16_f32 v58, v60, v61
    v_cvt_pk_bf16_f32 v59, v62, v63
    ds_write_b128 v15, v[56:59] offset:0
    v_cvt_pk_bf16_f32 v60, v64, v65
    v_cvt_pk_bf16_f32 v61, v66, v67
    v_cvt_pk_bf16_f32 v62, v68, v69
    v_cvt_pk_bf16_f32 v63, v70, v71
    ds_write_b128 v15, v[60:63] offset:1024
    v_cvt_pk_bf16_f32 v72, v72, v73
    v_cvt_pk_bf16_f32 v73, v74, v75
    v_cvt_pk_bf16_f32 v74, v76, v77
    v_cvt_pk_bf16_f32 v75, v78, v79
    ds_write_b128 v15, v[72:75] offset:2048
    v_cvt_pk_bf16_f32 v76, v80, v81
    v_cvt_pk_bf16_f32 v77, v82, v83
    v_cvt_pk_bf16_f32 v78, v84, v85
    v_cvt_pk_bf16_f32 v79, v86, v87
    ds_write_b128 v15, v[76:79] offset:3072
    v_cvt_pk_bf16_f32 v88, v88, v89
    v_cvt_pk_bf16_f32 v89, v90, v91
    v_cvt_pk_bf16_f32 v90, v92, v93
    v_cvt_pk_bf16_f32 v91, v94, v95
    ds_write_b128 v16, v[88:91] offset:0
    v_cvt_pk_bf16_f32 v92, v96, v97
    v_cvt_pk_bf16_f32 v93, v98, v99
    v_cvt_pk_bf16_f32 v94, v100, v101
    v_cvt_pk_bf16_f32 v95, v102, v103
    ds_write_b128 v16, v[92:95] offset:1024
    v_cvt_pk_bf16_f32 v104, v104, v105
    v_cvt_pk_bf16_f32 v105, v106, v107
    v_cvt_pk_bf16_f32 v106, v108, v109
    v_cvt_pk_bf16_f32 v107, v110, v111
    ds_write_b128 v16, v[104:107] offset:2048
    v_cvt_pk_bf16_f32 v108, v112, v113
    v_cvt_pk_bf16_f32 v109, v114, v115
    v_cvt_pk_bf16_f32 v110, v116, v117
    v_cvt_pk_bf16_f32 v111, v118, v119
    ds_write_b128 v16, v[108:111] offset:3072
    s_mov_b64 exec, 1
    buffer_load_dwordx2 v[20:21], v13, s[52:55], 0 offen sc1
    s_mov_b64 exec, -1
    s_waitcnt lgkmcnt(0)
    s_barrier
    s_cmp_lg_u32 s6, 0
    s_cbranch_scc1 L_B1
    v_add_u32 v10, 131072, v8
    v_add_u32 v11, 131072, v9
    ds_read_b64_tr_b16 v[24:25], v10 offset:0
    ds_read_b64_tr_b16 v[26:27], v10 offset:512
    ds_read_b64_tr_b16 v[28:29], v11 offset:0
    ds_read_b64_tr_b16 v[30:31], v11 offset:512
    ds_read_b128 v[88:91], v14 offset:0
    ds_read_b64_tr_b16 v[32:33], v10 offset:2048
    ds_read_b64_tr_b16 v[34:35], v10 offset:2560
    ds_read_b64_tr_b16 v[36:37], v11 offset:2048
    ds_read_b64_tr_b16 v[38:39], v11 offset:2560
    ds_read_b128 v[92:95], v14 offset:32
    ds_read_b64_tr_b16 v[40:41], v10 offset:4096
    ds_read_b64_tr_b16 v[42:43], v10 offset:4608
    ds_read_b64_tr_b16 v[44:45], v11 offset:4096
    ds_read_b64_tr_b16 v[46:47], v11 offset:4608
    ds_read_b128 v[96:99], v14 offset:64
    s_waitcnt lgkmcnt(10)
    v_mfma_f32_32x32x16_bf16 v[56:71], v[24:27], v[120:123], 0
    ds_read_b64_tr_b16 v[48:49], v10 offset:6144
    ds_read_b64_tr_b16 v[50:51], v10 offset:6656
    ds_read_b64_tr_b16 v[52:53], v11 offset:6144
    v_bfe_u32 v16, v0, 2, 2
    v_lshrrev_b32 v17, 5, v0
    v_mfma_f32_32x32x16_bf16 v[72:87], v[28:31], v[120:123], 0
    ds_read_b64_tr_b16 v[54:55], v11 offset:6656
    ds_read_b128 v[100:103], v14 offset:96
    v_lshl_add_u32 v16, v17, 2, v16
    v_lshlrev_b32 v16, 7, v16
    v_mfma_f32_32x32x16_bf16 v[104:119], v[88:91], v[120:123], 0
    v_bfe_u32 v17, v0, 4, 1
    v_lshlrev_b32 v17, 1, v17
CD_C0B0:
    s_waitcnt lgkmcnt(10)
    v_mfma_f32_32x32x16_bf16 v[56:71], v[32:35], v[124:127], v[56:71]
    ds_read_b64_tr_b16 v[24:25], v10 offset:8192
    ds_read_b64_tr_b16 v[26:27], v10 offset:8704
    ds_read_b64_tr_b16 v[28:29], v11 offset:8192
    v_bfe_u32 v18, v0, 1, 1
    v_or_b32 v17, v17, v18
    v_mfma_f32_32x32x16_bf16 v[72:87], v[36:39], v[124:127], v[72:87]
    ds_read_b64_tr_b16 v[30:31], v11 offset:8704
    ds_read_b128 v[88:91], v14 offset:128
    v_bfe_u32 v18, v0, 3, 1
    v_lshl_or_b32 v17, v18, 2, v17
    v_mfma_f32_32x32x16_bf16 v[104:119], v[92:95], v[124:127], v[104:119]
    v_lshl_add_u32 v16, v17, 4, v16
    v_and_b32 v18, 1, v0
CD_C0B1:
    s_waitcnt lgkmcnt(10)
    v_mfma_f32_32x32x16_bf16 v[56:71], v[40:43], v[128:131], v[56:71]
    ds_read_b64_tr_b16 v[32:33], v10 offset:10240
    ds_read_b64_tr_b16 v[34:35], v10 offset:10752
    ds_read_b64_tr_b16 v[36:37], v11 offset:10240
    v_lshl_add_u32 v16, v18, 3, v16
    s_lshr_b32 s58, s3, 1
    s_lshl_b32 s58, s58, 14
    v_add_u32 v16, s58, v16
    v_mfma_f32_32x32x16_bf16 v[72:87], v[44:47], v[128:131], v[72:87]
    ds_read_b64_tr_b16 v[38:39], v11 offset:10752
    ds_read_b128 v[92:95], v14 offset:160
    v_xor_b32 v17, 64, v16
    v_add_u32 v18, 0x10000, v16
    v_mfma_f32_32x32x16_bf16 v[104:119], v[96:99], v[128:131], v[104:119]
    v_add_u32 v19, 0x10000, v17
    v_lshrrev_b32 v3, 5, v0
    v_mul_u32_u24 v3, 40, v3
    v_sub_u32 v3, v0, v3
CD_C0B2:
    s_waitcnt lgkmcnt(10)
    v_mfma_f32_32x32x16_bf16 v[56:71], v[48:51], v[132:135], v[56:71]
    ds_read_b64_tr_b16 v[40:41], v10 offset:12288
    ds_read_b64_tr_b16 v[42:43], v10 offset:12800
    ds_read_b64_tr_b16 v[44:45], v11 offset:12288
    v_cmp_le_i32 s[64:65], 0, v3
    v_cmp_le_i32 s[66:67], 1, v3
    v_mfma_f32_32x32x16_bf16 v[72:87], v[52:55], v[132:135], v[72:87]
    ds_read_b64_tr_b16 v[46:47], v11 offset:12800
    ds_read_b128 v[96:99], v14 offset:192
    v_cmp_le_i32 s[68:69], 2, v3
    v_cmp_le_i32 s[70:71], 3, v3
    v_mfma_f32_32x32x16_bf16 v[104:119], v[100:103], v[132:135], v[104:119]
    v_cmp_le_i32 s[72:73], 4, v3
    v_cmp_le_i32 s[74:75], 5, v3
CD_C0B3:
    s_waitcnt lgkmcnt(10)
    v_mfma_f32_32x32x16_bf16 v[56:71], v[24:27], v[136:139], v[56:71]
    ds_read_b64_tr_b16 v[48:49], v10 offset:14336
    ds_read_b64_tr_b16 v[50:51], v10 offset:14848
    ds_read_b64_tr_b16 v[52:53], v11 offset:14336
    v_cmp_le_i32 s[76:77], 6, v3
    v_cmp_le_i32 s[78:79], 7, v3
    v_mfma_f32_32x32x16_bf16 v[72:87], v[28:31], v[136:139], v[72:87]
    ds_read_b64_tr_b16 v[54:55], v11 offset:14848
    ds_read_b128 v[100:103], v14 offset:224
    v_cmp_le_i32 s[80:81], 16, v3
    v_cmp_le_i32 s[82:83], 17, v3
    v_mfma_f32_32x32x16_bf16 v[104:119], v[88:91], v[136:139], v[104:119]
    v_cmp_le_i32 s[84:85], 18, v3
    v_cmp_le_i32 s[86:87], 19, v3
CD_C0B4:
    s_waitcnt lgkmcnt(10)
    s_barrier
    v_mfma_f32_32x32x16_bf16 v[56:71], v[32:35], v[140:143], v[56:71]
    ds_read_b64_tr_b16 v[24:25], v10 offset:16384
    ds_read_b64_tr_b16 v[26:27], v10 offset:16896
    ds_read_b64_tr_b16 v[28:29], v11 offset:16384
    v_cmp_le_i32 s[88:89], 20, v3
    v_cmp_le_i32 s[90:91], 21, v3
    v_mfma_f32_32x32x16_bf16 v[72:87], v[36:39], v[140:143], v[72:87]
    ds_read_b64_tr_b16 v[30:31], v11 offset:16896
    ds_read_b128 v[88:91], v14 offset:256
    v_cmp_le_i32 s[92:93], 22, v3
    v_cmp_le_i32 s[94:95], 23, v3
    v_mfma_f32_32x32x16_bf16 v[104:119], v[92:95], v[140:143], v[104:119]
    v_and_b32 v3, 0x1b, v0
    v_cmp_eq_u32 vcc, 16, v3
    v_mov_b32 v3, 0x3f803f80
    s_mov_b32 s56, 0xffff
    s_mov_b32 s57, 0xffff
    v_cndmask_b32 v120, 0, v3, vcc
    v_cndmask_b32 v121, 0, v3, vcc
    v_mov_b64 v[122:123], v[120:121]
CD_C0B5:
    s_waitcnt lgkmcnt(10)
    v_mfma_f32_32x32x16_bf16 v[56:71], v[40:43], v[144:147], v[56:71]
    ds_read_b64_tr_b16 v[32:33], v10 offset:18432
    ds_read_b64_tr_b16 v[34:35], v10 offset:18944
    ds_read_b64_tr_b16 v[36:37], v11 offset:18432
    v_mov_b64 v[124:125], v[120:121]
    v_mov_b64 v[126:127], v[120:121]
    v_mfma_f32_32x32x16_bf16 v[72:87], v[44:47], v[144:147], v[72:87]
    ds_read_b64_tr_b16 v[38:39], v11 offset:18944
    ds_read_b128 v[92:95], v14 offset:288
    v_mov_b64 v[128:129], v[120:121]
    v_mov_b64 v[130:131], v[120:121]
    v_mfma_f32_32x32x16_bf16 v[104:119], v[96:99], v[144:147], v[104:119]
    v_mov_b64 v[132:133], v[120:121]
    v_mov_b64 v[134:135], v[120:121]
CD_C0B6:
    s_waitcnt lgkmcnt(10)
    v_mfma_f32_32x32x16_bf16 v[56:71], v[48:51], v[148:151], v[56:71]
    ds_read_b64_tr_b16 v[40:41], v10 offset:20480
    ds_read_b64_tr_b16 v[42:43], v10 offset:20992
    ds_read_b64_tr_b16 v[44:45], v11 offset:20480
    v_mfma_f32_32x32x16_bf16 v[72:87], v[52:55], v[148:151], v[72:87]
    ds_read_b64_tr_b16 v[46:47], v11 offset:20992
    ds_read_b128 v[96:99], v14 offset:320
    v_mfma_f32_32x32x16_bf16 v[104:119], v[100:103], v[148:151], v[104:119]
CD_C0B7:
    s_waitcnt lgkmcnt(10)
    v_mfma_f32_32x32x16_bf16 v[56:71], v[24:27], v[152:155], v[56:71]
    ds_read_b64_tr_b16 v[48:49], v10 offset:22528
    ds_read_b64_tr_b16 v[50:51], v10 offset:23040
    ds_read_b64_tr_b16 v[52:53], v11 offset:22528
    v_mfma_f32_32x32x16_bf16 v[72:87], v[28:31], v[152:155], v[72:87]
    ds_read_b64_tr_b16 v[54:55], v11 offset:23040
    ds_read_b128 v[100:103], v14 offset:352
    v_mfma_f32_32x32x16_bf16 v[104:119], v[88:91], v[152:155], v[104:119]
CD_C0B8:
    s_waitcnt lgkmcnt(10)
    v_mfma_f32_32x32x16_bf16 v[56:71], v[32:35], v[156:159], v[56:71]
    v_add_u32 v10, 98304, v8
    v_add_u32 v11, 98304, v9
    ds_read_b64_tr_b16 v[24:25], v10 offset:0
    ds_read_b64_tr_b16 v[26:27], v10 offset:512
    v_mfma_f32_32x32x16_bf16 v[72:87], v[36:39], v[156:159], v[72:87]
    ds_read_b64_tr_b16 v[28:29], v11 offset:0
    ds_read_b64_tr_b16 v[30:31], v11 offset:512
    ds_read_b128 v[88:91], v14 offset:384
    v_mfma_f32_32x32x16_bf16 v[104:119], v[92:95], v[156:159], v[104:119]
CD_C0B9:
    s_waitcnt lgkmcnt(10)
    v_mfma_f32_32x32x16_bf16 v[56:71], v[40:43], v[160:163], v[56:71]
    ds_read_b64_tr_b16 v[32:33], v10 offset:2048
    ds_read_b64_tr_b16 v[34:35], v10 offset:2560
    ds_read_b64_tr_b16 v[36:37], v11 offset:2048
    v_mov_b32 v157, 0xff800000
    v_cndmask_b32 v136, v157, 0, s[64:65]
    v_mfma_f32_32x32x16_bf16 v[72:87], v[44:47], v[160:163], v[72:87]
    ds_read_b64_tr_b16 v[38:39], v11 offset:2560
    ds_read_b128 v[92:95], v14 offset:416
    v_cndmask_b32 v137, v157, 0, s[66:67]
    v_cndmask_b32 v138, v157, 0, s[68:69]
    v_mfma_f32_32x32x16_bf16 v[104:119], v[96:99], v[160:163], v[104:119]
    v_cndmask_b32 v139, v157, 0, s[70:71]
    v_cndmask_b32 v140, v157, 0, s[72:73]
CD_C0B10:
    s_waitcnt lgkmcnt(10)
    v_mfma_f32_32x32x16_bf16 v[56:71], v[48:51], v[164:167], v[56:71]
    ds_read_b64_tr_b16 v[40:41], v10 offset:4096
    ds_read_b64_tr_b16 v[42:43], v10 offset:4608
    ds_read_b64_tr_b16 v[44:45], v11 offset:4096
    v_cndmask_b32 v141, v157, 0, s[74:75]
    v_cndmask_b32 v142, v157, 0, s[76:77]
    v_mfma_f32_32x32x16_bf16 v[72:87], v[52:55], v[164:167], v[72:87]
    ds_read_b64_tr_b16 v[46:47], v11 offset:4608
    ds_read_b128 v[96:99], v14 offset:448
    v_cndmask_b32 v143, v157, 0, s[78:79]
    v_cndmask_b32 v144, v157, 0, s[80:81]
    v_mfma_f32_32x32x16_bf16 v[104:119], v[100:103], v[164:167], v[104:119]
    v_cndmask_b32 v145, v157, 0, s[82:83]
    v_cndmask_b32 v146, v157, 0, s[84:85]
CD_C0B11:
    s_waitcnt lgkmcnt(10)
    v_mfma_f32_32x32x16_bf16 v[56:71], v[24:27], v[168:171], v[56:71]
    ds_read_b64_tr_b16 v[48:49], v10 offset:6144
    ds_read_b64_tr_b16 v[50:51], v10 offset:6656
    ds_read_b64_tr_b16 v[52:53], v11 offset:6144
    v_cndmask_b32 v147, v157, 0, s[86:87]
    v_cndmask_b32 v148, v157, 0, s[88:89]
    v_mfma_f32_32x32x16_bf16 v[72:87], v[28:31], v[168:171], v[72:87]
    ds_read_b64_tr_b16 v[54:55], v11 offset:6656
    ds_read_b128 v[100:103], v14 offset:480
    v_cndmask_b32 v149, v157, 0, s[90:91]
    v_cndmask_b32 v150, v157, 0, s[92:93]
    v_mfma_f32_32x32x16_bf16 v[104:119], v[88:91], v[168:171], v[104:119]
    v_cndmask_b32 v151, v157, 0, s[94:95]
    v_mov_b32 v152, 0xdddddddd
CD_C0B12:
    s_waitcnt lgkmcnt(10)
    v_mfma_f32_32x32x16_bf16 v[56:71], v[32:35], v[172:175], v[56:71]
    ds_read_b64_tr_b16 v[24:25], v10 offset:8192
    ds_read_b64_tr_b16 v[26:27], v10 offset:8704
    v_mov_b32 v153, v2
    s_lshl_b32 s58, s3, 11
    s_add_u32 s58, s58, 131072
    v_add_u32 v154, s58, v2
    v_mfma_f32_32x32x16_bf16 v[72:87], v[36:39], v[172:175], v[72:87]
    ds_read_b64_tr_b16 v[28:29], v11 offset:8192
    ds_read_b64_tr_b16 v[30:31], v11 offset:8704
    s_lshl_b32 s58, s3, 10
    s_add_u32 s58, s58, 81920
    v_add_u32 v156, s58, v2
    s_lshl_b32 s58, s9, 1
    v_add_u32 v158, s58, v0
    v_mfma_f32_32x32x16_bf16 v[104:119], v[92:95], v[172:175], v[104:119]
    v_and_b32 v158, 15, v158
    s_and_b32 s58, s3, 1
    s_lshl_b32 s58, s58, 6
    s_lshr_b32 s59, s3, 1
    s_add_u32 s58, s58, s59
    v_lshl_add_u32 v158, v158, 2, s58
CD_C0B13:
    s_waitcnt lgkmcnt(9)
    v_mfma_f32_32x32x16_bf16 v[56:71], v[40:43], v[176:179], v[56:71]
    ds_read_b64_tr_b16 v[32:33], v10 offset:10240
    ds_read_b64_tr_b16 v[34:35], v10 offset:10752
    v_and_b32 v159, 1, v0
    s_lshl_b32 s58, s9, 3
    s_lshl_b32 s59, s3, 1
    s_add_u32 s58, s58, s59
    s_sub_i32 s58, s58, 8
    s_max_i32 s58, s58, 0
    s_add_u32 s58, s58, 1024
    v_add_u32 v159, s58, v159
    v_mfma_f32_32x32x16_bf16 v[72:87], v[44:47], v[176:179], v[72:87]
    ds_read_b64_tr_b16 v[36:37], v11 offset:10240
    ds_read_b64_tr_b16 v[38:39], v11 offset:10752
    v_bfe_u32 v3, v0, 1, 1
    v_lshl_add_u32 v159, v3, 6, v159
    v_mfma_f32_32x32x16_bf16 v[104:119], v[96:99], v[176:179], v[104:119]
    v_cmp_gt_u32 vcc, 16, v0
    v_and_b32 v3, 1, v0
    v_mul_u32_u24 v3, 1088, v3
    v_cndmask_b32 v158, v159, v158, vcc
    v_bfe_u32 v159, v0, 1, 1
    v_lshl_add_u32 v3, v159, 6, v3
CD_C0B14:
    s_waitcnt lgkmcnt(8)
    v_mfma_f32_32x32x16_bf16 v[56:71], v[48:51], v[180:183], v[56:71]
    ds_read_b64_tr_b16 v[40:41], v10 offset:12288
    ds_read_b64_tr_b16 v[42:43], v10 offset:12800
    v_cmp_le_u32 vcc, 20, v0
    s_add_u32 s58, s10, 1024
    v_add_u32 v159, s58, v3
    s_nop 0
    v_cndmask_b32 v158, v158, v159, vcc
    v_mfma_f32_32x32x16_bf16 v[72:87], v[52:55], v[180:183], v[72:87]
    ds_read_b64_tr_b16 v[44:45], v11 offset:12288
    ds_read_b64_tr_b16 v[46:47], v11 offset:12800
    v_mfma_f32_32x32x16_bf16 v[104:119], v[100:103], v[180:183], v[104:119]
CD_C0B15:
    s_waitcnt lgkmcnt(8)
    v_mfma_f32_32x32x16_bf16 v[56:71], v[24:27], v[184:187], v[56:71]
    ds_read_b64_tr_b16 v[48:49], v10 offset:14336
    ds_read_b64_tr_b16 v[50:51], v10 offset:14848
    v_mfma_f32_32x32x16_bf16 v[72:87], v[28:31], v[184:187], v[72:87]
    ds_read_b64_tr_b16 v[52:53], v11 offset:14336
    ds_read_b64_tr_b16 v[54:55], v11 offset:14848
CD_C0B16:
    s_waitcnt lgkmcnt(8)
    v_mfma_f32_32x32x16_bf16 v[56:71], v[32:35], v[188:191], v[56:71]
    ds_read_b64_tr_b16 v[24:25], v10 offset:16384
    ds_read_b64_tr_b16 v[26:27], v10 offset:16896
    v_mfma_f32_32x32x16_bf16 v[72:87], v[36:39], v[188:191], v[72:87]
    ds_read_b64_tr_b16 v[28:29], v11 offset:16384
    ds_read_b64_tr_b16 v[30:31], v11 offset:16896
CD_C0B17:
    s_waitcnt lgkmcnt(8)
    v_mfma_f32_32x32x16_bf16 v[56:71], v[40:43], v[192:195], v[56:71]
    ds_read_b64_tr_b16 v[32:33], v10 offset:18432
    ds_read_b64_tr_b16 v[34:35], v10 offset:18944
    v_mov_b64 v[160:161], 0
    v_mov_b64 v[162:163], 0
    v_mfma_f32_32x32x16_bf16 v[72:87], v[44:47], v[192:195], v[72:87]
    ds_read_b64_tr_b16 v[36:37], v11 offset:18432
    ds_read_b64_tr_b16 v[38:39], v11 offset:18944
    v_mov_b64 v[164:165], 0
    v_mov_b64 v[166:167], 0
CD_C0B18:
    s_waitcnt lgkmcnt(8)
    v_mfma_f32_32x32x16_bf16 v[56:71], v[48:51], v[196:199], v[56:71]
    ds_read_b64_tr_b16 v[40:41], v10 offset:20480
    ds_read_b64_tr_b16 v[42:43], v10 offset:20992
    v_mov_b64 v[168:169], 0
    v_mov_b64 v[170:171], 0
    v_mfma_f32_32x32x16_bf16 v[72:87], v[52:55], v[196:199], v[72:87]
    ds_read_b64_tr_b16 v[44:45], v11 offset:20480
    ds_read_b64_tr_b16 v[46:47], v11 offset:20992
    v_mov_b64 v[172:173], 0
    v_mov_b64 v[174:175], 0
CD_C0B19:
    s_waitcnt lgkmcnt(8)
    v_mfma_f32_32x32x16_bf16 v[56:71], v[24:27], v[200:203], v[56:71]
    ds_read_b64_tr_b16 v[48:49], v10 offset:22528
    ds_read_b64_tr_b16 v[50:51], v10 offset:23040
    v_mov_b64 v[176:177], 0
    v_mov_b64 v[178:179], 0
    v_mfma_f32_32x32x16_bf16 v[72:87], v[28:31], v[200:203], v[72:87]
    ds_read_b64_tr_b16 v[52:53], v11 offset:22528
    ds_read_b64_tr_b16 v[54:55], v11 offset:23040
    v_mov_b64 v[180:181], 0
    v_mov_b64 v[182:183], 0
CD_C0B20:
    s_waitcnt lgkmcnt(8)
    v_mfma_f32_32x32x16_bf16 v[56:71], v[32:35], v[204:207], v[56:71]
    ds_read_b64_tr_b16 v[24:25], v10 offset:24576
    ds_read_b64_tr_b16 v[26:27], v10 offset:25088
    v_mov_b64 v[184:185], 0
    v_mov_b64 v[186:187], 0
    v_mfma_f32_32x32x16_bf16 v[72:87], v[36:39], v[204:207], v[72:87]
    ds_read_b64_tr_b16 v[28:29], v11 offset:24576
    ds_read_b64_tr_b16 v[30:31], v11 offset:25088
    v_mov_b64 v[188:189], 0
    v_mov_b64 v[190:191], 0
CD_C0B21:
    s_waitcnt lgkmcnt(8)
    v_mfma_f32_32x32x16_bf16 v[56:71], v[40:43], v[208:211], v[56:71]
    ds_read_b64_tr_b16 v[32:33], v10 offset:26624
    ds_read_b64_tr_b16 v[34:35], v10 offset:27136
    v_lshrrev_b32 v159, 3, v0
    v_bfe_u32 v3, v0, 4, 1
    v_lshlrev_b32 v3, 2, v3
    v_xor_b32 v3, v3, v0
    v_mfma_f32_32x32x16_bf16 v[72:87], v[44:47], v[208:211], v[72:87]
    ds_read_b64_tr_b16 v[36:37], v11 offset:26624
    ds_read_b64_tr_b16 v[38:39], v11 offset:27136
    v_and_b32 v3, 7, v3
    v_lshlrev_b32 v3, 4, v3
CD_C0B22:
    s_waitcnt lgkmcnt(8)
    v_mfma_f32_32x32x16_bf16 v[56:71], v[48:51], v[212:215], v[56:71]
    ds_read_b64_tr_b16 v[40:41], v10 offset:28672
    ds_read_b64_tr_b16 v[42:43], v10 offset:29184
    v_mfma_f32_32x32x16_bf16 v[72:87], v[52:55], v[212:215], v[72:87]
    ds_read_b64_tr_b16 v[44:45], v11 offset:28672
    ds_read_b64_tr_b16 v[46:47], v11 offset:29184
CD_C0B23:
    s_waitcnt lgkmcnt(8)
    v_mfma_f32_32x32x16_bf16 v[56:71], v[24:27], v[216:219], v[56:71]
    ds_read_b64_tr_b16 v[48:49], v10 offset:30720
    ds_read_b64_tr_b16 v[50:51], v10 offset:31232
    v_mfma_f32_32x32x16_bf16 v[72:87], v[28:31], v[216:219], v[72:87]
    ds_read_b64_tr_b16 v[52:53], v11 offset:30720
    ds_read_b64_tr_b16 v[54:55], v11 offset:31232
CD_C0B24:
    s_waitcnt vmcnt(0)
    v_readfirstlane_b32 s12, v20
    v_readfirstlane_b32 s13, v21
    s_cmp_eq_u32 s12, 0
    s_cbranch_scc1 Lnp_13
Lnd_14:
    s_waitcnt lgkmcnt(8)
    v_mfma_f32_32x32x16_bf16 v[56:71], v[32:35], v[220:223], v[56:71]
    v_add_u32 v10, 90112, v8
    v_add_u32 v11, 90112, v9
    ds_read_b64_tr_b16 v[24:25], v10 offset:0
    v_and_b32 v20, 15, v0
    v_lshrrev_b32 v21, 5, v0
    v_xor_b32 v20, v20, v21
    v_and_b32 v21, 31, v0
    v_lshlrev_b32 v21, 8, v21
    v_lshl_add_u32 v20, v20, 4, v21
    v_mfma_f32_32x32x16_bf16 v[72:87], v[36:39], v[220:223], v[72:87]
    ds_read_b64_tr_b16 v[26:27], v10 offset:512
    ds_read_b64_tr_b16 v[28:29], v11 offset:0
    ds_read_b64_tr_b16 v[30:31], v11 offset:512
    s_lshl_b32 s58, s3, 13
    s_add_u32 s58, s58, 0x10000
    v_add_u32 v20, s58, v20
    v_lshrrev_b32 v21, 3, v0
    s_lshl_b32 s58, s3, 3
    v_add_u32 v21, s58, v21
CD_C0B25:
    s_waitcnt lgkmcnt(8)
    v_mfma_f32_32x32x16_bf16 v[56:71], v[40:43], v[224:227], v[56:71]
    ds_read_b64_tr_b16 v[32:33], v10 offset:2048
    ds_read_b64_tr_b16 v[34:35], v10 offset:2560
    v_and_b32 v22, 7, v0
    v_lshlrev_b32 v22, 1, v22
    v_xor_b32 v22, v22, v21
    v_and_b32 v22, 15, v22
    v_lshlrev_b32 v22, 4, v22
    v_lshl_add_u32 v22, v21, 8, v22
    v_mfma_f32_32x32x16_bf16 v[72:87], v[44:47], v[224:227], v[72:87]
    ds_read_b64_tr_b16 v[36:37], v11 offset:2048
    ds_read_b64_tr_b16 v[38:39], v11 offset:2560
    v_add_u32 v22, 0x10000, v22
    v_xor_b32 v23, 16, v22
CD_C0B26:
    s_waitcnt lgkmcnt(8)
    v_mfma_f32_32x32x16_bf16 v[56:71], v[48:51], v[228:231], v[56:71]
    ds_read_b64_tr_b16 v[40:41], v10 offset:4096
    ds_read_b64_tr_b16 v[42:43], v10 offset:4608
    v_mfma_f32_32x32x16_bf16 v[72:87], v[52:55], v[228:231], v[72:87]
    ds_read_b64_tr_b16 v[44:45], v11 offset:4096
    ds_read_b64_tr_b16 v[46:47], v11 offset:4608
CD_C0B27:
    s_waitcnt lgkmcnt(8)
    v_mfma_f32_32x32x16_bf16 v[56:71], v[24:27], v[232:235], v[56:71]
    ds_read_b64_tr_b16 v[48:49], v10 offset:6144
    ds_read_b64_tr_b16 v[50:51], v10 offset:6656
    v_mfma_f32_32x32x16_bf16 v[72:87], v[28:31], v[232:235], v[72:87]
    ds_read_b64_tr_b16 v[52:53], v11 offset:6144
    ds_read_b64_tr_b16 v[54:55], v11 offset:6656
CD_C0B28:
    s_waitcnt lgkmcnt(8)
    v_mfma_f32_32x32x16_bf16 v[56:71], v[32:35], v[236:239], v[56:71]
    v_mfma_f32_32x32x16_bf16 v[72:87], v[36:39], v[236:239], v[72:87]
CD_C0B29:
    s_waitcnt lgkmcnt(4)
    v_mfma_f32_32x32x16_bf16 v[56:71], v[40:43], v[240:243], v[56:71]
    v_mfma_f32_32x32x16_bf16 v[72:87], v[44:47], v[240:243], v[72:87]
CD_C0B30:
    s_waitcnt lgkmcnt(0)
    v_mfma_f32_32x32x16_bf16 v[56:71], v[48:51], v[244:247], v[56:71]
    v_and_b32 v243, 7, v0
    v_lshlrev_b32 v243, 4, v243
    v_lshl_add_u32 v243, v21, 10, v243
    v_mfma_f32_32x32x16_bf16 v[72:87], v[52:55], v[244:247], v[72:87]
CD_C0B31:
    v_bfe_u32 v247, v0, 2, 1
    v_lshlrev_b32 v247, 7, v247
    v_and_or_b32 v247, v0, 3, v247
    v_lshlrev_b32 v247, 2, v247
    v_add_u32 v247, 131072, v247
    v_lshl_add_u32 v244, v159, 10, v3
    v_mul_u32_u24 v246, 128, v158
    v_mul_u32_u24 v245, 128, v0
    v_mov_b32 v241, v12
    s_mov_b32 s28, s18
    s_mov_b32 s29, s26
    s_mov_b32 s30, s27
    s_add_u32 s31, s11, 131072
    s_mov_b32 s25, 2
    v_lshlrev_b32 v242, 2, v1
    s_nop 4
    v_cvt_pk_bf16_f32 v224, v56, v57
    v_cvt_pk_bf16_f32 v225, v58, v59
    v_cvt_pk_bf16_f32 v226, v60, v61
    v_cvt_pk_bf16_f32 v227, v62, v63
    v_cvt_pk_bf16_f32 v228, v64, v65
    v_cvt_pk_bf16_f32 v229, v66, v67
    v_cvt_pk_bf16_f32 v230, v68, v69
    v_cvt_pk_bf16_f32 v231, v70, v71
    v_cvt_pk_bf16_f32 v232, v72, v73
    v_cvt_pk_bf16_f32 v233, v74, v75
    v_cvt_pk_bf16_f32 v234, v76, v77
    v_cvt_pk_bf16_f32 v235, v78, v79
    v_cvt_pk_bf16_f32 v236, v80, v81
    v_cvt_pk_bf16_f32 v237, v82, v83
    v_cvt_pk_bf16_f32 v238, v84, v85
    v_cvt_pk_bf16_f32 v239, v86, v87
    v_mov_b32 v240, v104
    s_branch L_P2
L_AN:
    s_mov_b32 s28, s66
    s_mov_b32 s29, s67
    s_mov_b32 s30, 0x180000
    s_mov_b32 s31, 0x20000
    s_lshl_b32 s86, s4, 2
    s_add_u32 s86, s86, s3
    s_mul_i32 s86, s86, 24576
    s_lshl_b32 s87, s5, 7
    s_add_u32 s86, s86, s87
    s_lshl_b32 s87, s6, 10
    s_add_u32 s86, s86, s87
    v_mul_u32_u24 v24, 3072, v0
    s_mov_b64 exec, 0xff
    buffer_load_dword v248, v24, s[28:31], s86 offen offset:1024
    s_mov_b64 exec, -1
    s_barrier
    ds_read_b128 v[120:123], v4
    ds_read_b64_tr_b16 v[24:25], v10 offset:0
    ds_read_b64_tr_b16 v[26:27], v10 offset:512
    ds_read_b64_tr_b16 v[28:29], v11 offset:0
    ds_read_b64_tr_b16 v[30:31], v11 offset:512
    ds_read_b128 v[40:43], v16
    s_waitcnt lgkmcnt(3)
    v_mfma_f32_32x32x16_bf16 v[56:71], v[120:123], v[24:27], 0
    ds_read_b128 v[124:127], v5
    ds_read_b64_tr_b16 v[32:33], v10 offset:2048
    s_waitcnt lgkmcnt(3)
    v_mfma_f32_32x32x16_bf16 v[72:87], v[120:123], v[28:31], 0
    ds_read_b64_tr_b16 v[34:35], v10 offset:2560
    ds_read_b64_tr_b16 v[36:37], v11 offset:2048
    s_waitcnt lgkmcnt(4)
    v_mfma_f32_32x32x16_bf16 v[88:103], v[40:43], v[24:27], 0
    ds_read_b64_tr_b16 v[38:39], v11 offset:2560
    ds_read_b128 v[44:47], v17
    v_mfma_f32_32x32x16_bf16 v[104:119], v[40:43], v[28:31], 0
    s_mov_b32 s32, s82
    s_mov_b32 s33, s83
    s_mov_b32 s34, 0x1800000
    s_mov_b32 s35, 0x20000
CD_C1A0:
    s_waitcnt lgkmcnt(3)
    v_mfma_f32_32x32x16_bf16 v[56:71], v[124:127], v[32:35], v[56:71]
    ds_read_b128 v[128:131], v6
    ds_read_b64_tr_b16 v[24:25], v10 offset:4096
    s_waitcnt lgkmcnt(3)
    v_mfma_f32_32x32x16_bf16 v[72:87], v[124:127], v[36:39], v[72:87]
    ds_read_b64_tr_b16 v[26:27], v10 offset:4608
    ds_read_b64_tr_b16 v[28:29], v11 offset:4096
    s_waitcnt lgkmcnt(4)
    v_mfma_f32_32x32x16_bf16 v[88:103], v[44:47], v[32:35], v[88:103]
    ds_read_b64_tr_b16 v[30:31], v11 offset:4608
    ds_read_b128 v[40:43], v18
    v_mfma_f32_32x32x16_bf16 v[104:119], v[44:47], v[36:39], v[104:119]
    s_mov_b32 s52, s80
    s_mov_b32 s53, s81
    s_mov_b32 s54, 0x100
    s_mov_b32 s55, 0x20000
CD_C1A1:
    s_branch SK_C1A1
.p2align 12
PG_C1A1:
    s_setpc_b64 s[100:101]
SK_C1A1:
    s_waitcnt lgkmcnt(3)
    v_mfma_f32_32x32x16_bf16 v[56:71], v[128:131], v[24:27], v[56:71]
    ds_read_b128 v[132:135], v7
    ds_read_b64_tr_b16 v[32:33], v10 offset:6144
    s_waitcnt lgkmcnt(3)
    v_mfma_f32_32x32x16_bf16 v[72:87], v[128:131], v[28:31], v[72:87]
    ds_read_b64_tr_b16 v[34:35], v10 offset:6656
    ds_read_b64_tr_b16 v[36:37], v11 offset:6144
    s_waitcnt lgkmcnt(4)
    v_mfma_f32_32x32x16_bf16 v[88:103], v[40:43], v[24:27], v[88:103]
    ds_read_b64_tr_b16 v[38:39], v11 offset:6656
    ds_read_b128 v[44:47], v19
    v_mfma_f32_32x32x16_bf16 v[104:119], v[40:43], v[28:31], v[104:119]
    s_mov_b32 s36, s78
    s_mov_b32 s37, s79
    s_mov_b32 s38, 0x200000
    s_mov_b32 s39, 0x20000
CD_C1A2:
    s_waitcnt lgkmcnt(3)
    v_mfma_f32_32x32x16_bf16 v[56:71], v[132:135], v[32:35], v[56:71]
    v_subrev_u32 v4, 32768, v4
    v_subrev_u32 v16, 32768, v16
    v_subrev_u32 v10, 32768, v10
    v_subrev_u32 v11, 32768, v11
    s_waitcnt lgkmcnt(0)
    v_mfma_f32_32x32x16_bf16 v[72:87], v[132:135], v[36:39], v[72:87]
    s_barrier
    ds_read_b128 v[136:139], v4
    ds_read_b64_tr_b16 v[24:25], v10 offset:0
    ds_read_b64_tr_b16 v[26:27], v10 offset:512
    v_mfma_f32_32x32x16_bf16 v[88:103], v[44:47], v[32:35], v[88:103]
    ds_read_b64_tr_b16 v[28:29], v11 offset:0
    ds_read_b64_tr_b16 v[30:31], v11 offset:512
    ds_read_b128 v[40:43], v16
    v_mfma_f32_32x32x16_bf16 v[104:119], v[44:47], v[36:39], v[104:119]
    v_subrev_u32 v5, 32768, v5
    v_subrev_u32 v6, 32768, v6
    v_subrev_u32 v7, 32768, v7
    v_subrev_u32 v17, 32768, v17
    v_subrev_u32 v18, 32768, v18
    v_subrev_u32 v19, 32768, v19
CD_C1A3:
    s_waitcnt lgkmcnt(3)
    v_mfma_f32_32x32x16_bf16 v[56:71], v[136:139], v[24:27], v[56:71]
    ds_read_b128 v[140:143], v5
    ds_read_b64_tr_b16 v[32:33], v10 offset:2048
    s_waitcnt lgkmcnt(3)
    v_mfma_f32_32x32x16_bf16 v[72:87], v[136:139], v[28:31], v[72:87]
    ds_read_b64_tr_b16 v[34:35], v10 offset:2560
    ds_read_b64_tr_b16 v[36:37], v11 offset:2048
    s_waitcnt lgkmcnt(4)
    v_mfma_f32_32x32x16_bf16 v[88:103], v[40:43], v[24:27], v[88:103]
    ds_read_b64_tr_b16 v[38:39], v11 offset:2560
    ds_read_b128 v[44:47], v17
    v_mfma_f32_32x32x16_bf16 v[104:119], v[40:43], v[28:31], v[104:119]
    s_mov_b32 s40, s68
    s_mov_b32 s41, s69
    s_mov_b32 s42, 0x80000
    s_mov_b32 s43, 0x20000
CD_C1A4:
    s_waitcnt lgkmcnt(3)
    v_mfma_f32_32x32x16_bf16 v[56:71], v[140:143], v[32:35], v[56:71]
    ds_read_b128 v[144:147], v6
    ds_read_b64_tr_b16 v[24:25], v10 offset:4096
    s_waitcnt lgkmcnt(3)
    v_mfma_f32_32x32x16_bf16 v[72:87], v[140:143], v[36:39], v[72:87]
    ds_read_b64_tr_b16 v[26:27], v10 offset:4608
    ds_read_b64_tr_b16 v[28:29], v11 offset:4096
    s_waitcnt lgkmcnt(4)
    v_mfma_f32_32x32x16_bf16 v[88:103], v[44:47], v[32:35], v[88:103]
    ds_read_b64_tr_b16 v[30:31], v11 offset:4608
    ds_read_b128 v[40:43], v18
    v_mfma_f32_32x32x16_bf16 v[104:119], v[44:47], v[36:39], v[104:119]
    s_mov_b32 s44, s74
    s_mov_b32 s45, s75
    s_mov_b32 s46, 0x80000
    s_mov_b32 s47, 0x20000
CD_C1A5:
    s_waitcnt lgkmcnt(3)
    v_mfma_f32_32x32x16_bf16 v[56:71], v[144:147], v[24:27], v[56:71]
    ds_read_b128 v[148:151], v7
    ds_read_b64_tr_b16 v[32:33], v10 offset:6144
    s_waitcnt lgkmcnt(3)
    v_mfma_f32_32x32x16_bf16 v[72:87], v[144:147], v[28:31], v[72:87]
    ds_read_b64_tr_b16 v[34:35], v10 offset:6656
    ds_read_b64_tr_b16 v[36:37], v11 offset:6144
    s_waitcnt lgkmcnt(4)
    v_mfma_f32_32x32x16_bf16 v[88:103], v[40:43], v[24:27], v[88:103]
    ds_read_b64_tr_b16 v[38:39], v11 offset:6656
    ds_read_b128 v[44:47], v19
    v_mfma_f32_32x32x16_bf16 v[104:119], v[40:43], v[28:31], v[104:119]
    s_lshl_b32 s8, s5, 2
    s_bfe_u32 s60, s2, 0x20003
    s_add_u32 s8, s8, s60
    s_lshr_b32 s9, s2, 5
    s_lshl_b32 s10, s9, 3
    s_add_u32 s10, s10, s3
CD_C1A6:
    s_waitcnt lgkmcnt(3)
    v_mfma_f32_32x32x16_bf16 v[56:71], v[148:151], v[32:35], v[56:71]
    v_subrev_u32 v4, 32768, v4
    v_subrev_u32 v16, 32768, v16
    v_subrev_u32 v10, 32768, v10
    v_subrev_u32 v11, 32768, v11
    s_waitcnt lgkmcnt(0)
    v_mfma_f32_32x32x16_bf16 v[72:87], v[148:151], v[36:39], v[72:87]
    s_barrier
    ds_read_b128 v[152:155], v4
    ds_read_b64_tr_b16 v[24:25], v10 offset:0
    ds_read_b64_tr_b16 v[26:27], v10 offset:512
    v_mfma_f32_32x32x16_bf16 v[88:103], v[44:47], v[32:35], v[88:103]
    ds_read_b64_tr_b16 v[28:29], v11 offset:0
    ds_read_b64_tr_b16 v[30:31], v11 offset:512
    ds_read_b128 v[40:43], v16
    v_mfma_f32_32x32x16_bf16 v[104:119], v[44:47], v[36:39], v[104:119]
    v_subrev_u32 v5, 32768, v5
    v_subrev_u32 v6, 32768, v6
    v_subrev_u32 v7, 32768, v7
    v_subrev_u32 v17, 32768, v17
    v_subrev_u32 v18, 32768, v18
    v_subrev_u32 v19, 32768, v19
CD_C1A7:
    s_waitcnt lgkmcnt(3)
    v_mfma_f32_32x32x16_bf16 v[56:71], v[152:155], v[24:27], v[56:71]
    ds_read_b128 v[156:159], v5
    ds_read_b64_tr_b16 v[32:33], v10 offset:2048
    s_waitcnt lgkmcnt(3)
    v_mfma_f32_32x32x16_bf16 v[72:87], v[152:155], v[28:31], v[72:87]
    ds_read_b64_tr_b16 v[34:35], v10 offset:2560
    ds_read_b64_tr_b16 v[36:37], v11 offset:2048
    s_waitcnt lgkmcnt(4)
    v_mfma_f32_32x32x16_bf16 v[88:103], v[40:43], v[24:27], v[88:103]
    ds_read_b64_tr_b16 v[38:39], v11 offset:2560
    ds_read_b128 v[44:47], v17
    v_mfma_f32_32x32x16_bf16 v[104:119], v[40:43], v[28:31], v[104:119]
    v_lshlrev_b32 v2, 4, v0
CD_C1A8:
    s_waitcnt lgkmcnt(3)
    v_mfma_f32_32x32x16_bf16 v[56:71], v[156:159], v[32:35], v[56:71]
    ds_read_b128 v[160:163], v6
    ds_read_b64_tr_b16 v[24:25], v10 offset:4096
    s_waitcnt lgkmcnt(3)
    v_mfma_f32_32x32x16_bf16 v[72:87], v[156:159], v[36:39], v[72:87]
    ds_read_b64_tr_b16 v[26:27], v10 offset:4608
    ds_read_b64_tr_b16 v[28:29], v11 offset:4096
    s_waitcnt lgkmcnt(4)
    v_mfma_f32_32x32x16_bf16 v[88:103], v[44:47], v[32:35], v[88:103]
    ds_read_b64_tr_b16 v[30:31], v11 offset:4608
    ds_read_b128 v[40:43], v18
    v_mfma_f32_32x32x16_bf16 v[104:119], v[44:47], v[36:39], v[104:119]
    s_lshl_b32 s16, s4, 2
    s_add_u32 s16, s16, s15
    s_lshl_b32 s17, s5, 8
    s_add_u32 s17, s17, s16
CD_C1A9:
    s_waitcnt lgkmcnt(3)
    v_mfma_f32_32x32x16_bf16 v[56:71], v[160:163], v[24:27], v[56:71]
    ds_read_b128 v[164:167], v7
    ds_read_b64_tr_b16 v[32:33], v10 offset:6144
    s_waitcnt lgkmcnt(3)
    v_mfma_f32_32x32x16_bf16 v[72:87], v[160:163], v[28:31], v[72:87]
    ds_read_b64_tr_b16 v[34:35], v10 offset:6656
    ds_read_b64_tr_b16 v[36:37], v11 offset:6144
    s_waitcnt lgkmcnt(4)
    v_mfma_f32_32x32x16_bf16 v[88:103], v[40:43], v[24:27], v[88:103]
    ds_read_b64_tr_b16 v[38:39], v11 offset:6656
    ds_read_b128 v[44:47], v19
    v_mfma_f32_32x32x16_bf16 v[104:119], v[40:43], v[28:31], v[104:119]
    s_lshl_b32 s18, s17, 11
    s_add_u32 s18, s18, 0x400000
    s_lshl_b32 s19, s17, 10
    s_xor_b32 s20, s6, 1
CD_C1A10:
    s_waitcnt lgkmcnt(3)
    v_mfma_f32_32x32x16_bf16 v[56:71], v[164:167], v[32:35], v[56:71]
    v_subrev_u32 v4, 32768, v4
    v_subrev_u32 v16, 32768, v16
    v_subrev_u32 v10, 32768, v10
    v_subrev_u32 v11, 32768, v11
    s_waitcnt lgkmcnt(0)
    v_mfma_f32_32x32x16_bf16 v[72:87], v[164:167], v[36:39], v[72:87]
    s_barrier
    ds_read_b128 v[168:171], v4
    ds_read_b64_tr_b16 v[24:25], v10 offset:0
    ds_read_b64_tr_b16 v[26:27], v10 offset:512
    v_mfma_f32_32x32x16_bf16 v[88:103], v[44:47], v[32:35], v[88:103]
    ds_read_b64_tr_b16 v[28:29], v11 offset:0
    ds_read_b64_tr_b16 v[30:31], v11 offset:512
    ds_read_b128 v[40:43], v16
    v_mfma_f32_32x32x16_bf16 v[104:119], v[44:47], v[36:39], v[104:119]
    v_subrev_u32 v5, 32768, v5
    v_subrev_u32 v6, 32768, v6
    v_subrev_u32 v7, 32768, v7
    v_subrev_u32 v17, 32768, v17
    v_subrev_u32 v18, 32768, v18
    v_subrev_u32 v19, 32768, v19
CD_C1A11:
    s_waitcnt lgkmcnt(3)
    v_mfma_f32_32x32x16_bf16 v[56:71], v[168:171], v[24:27], v[56:71]
    ds_read_b128 v[172:175], v5
    ds_read_b64_tr_b16 v[32:33], v10 offset:2048
    s_waitcnt lgkmcnt(3)
    v_mfma_f32_32x32x16_bf16 v[72:87], v[168:171], v[28:31], v[72:87]
    ds_read_b64_tr_b16 v[34:35], v10 offset:2560
    ds_read_b64_tr_b16 v[36:37], v11 offset:2048
    s_waitcnt lgkmcnt(4)
    v_mfma_f32_32x32x16_bf16 v[88:103], v[40:43], v[24:27], v[88:103]
    ds_read_b64_tr_b16 v[38:39], v11 offset:2560
    ds_read_b128 v[44:47], v17
    v_mfma_f32_32x32x16_bf16 v[104:119], v[40:43], v[28:31], v[104:119]
    s_lshl_b32 s20, s20, 21
    s_add_u32 s19, s19, s20
    s_lshl_b32 s11, s5, 1
    s_add_u32 s11, s11, s6
CD_C1A12:
    s_waitcnt lgkmcnt(3)
    v_mfma_f32_32x32x16_bf16 v[56:71], v[172:175], v[32:35], v[56:71]
    ds_read_b128 v[176:179], v6
    ds_read_b64_tr_b16 v[24:25], v10 offset:4096
    s_waitcnt lgkmcnt(3)
    v_mfma_f32_32x32x16_bf16 v[72:87], v[172:175], v[36:39], v[72:87]
    ds_read_b64_tr_b16 v[26:27], v10 offset:4608
    ds_read_b64_tr_b16 v[28:29], v11 offset:4096
    s_waitcnt lgkmcnt(4)
    v_mfma_f32_32x32x16_bf16 v[88:103], v[44:47], v[32:35], v[88:103]
    ds_read_b64_tr_b16 v[30:31], v11 offset:4608
    ds_read_b128 v[40:43], v18
    v_mfma_f32_32x32x16_bf16 v[104:119], v[44:47], v[36:39], v[104:119]
    s_lshl_b32 s11, s11, 6
    s_add_u32 s11, s11, s16
    s_mul_i32 s11, s11, 128
    s_add_u32 s11, s11, 0x1080000
CD_C1A13:
    s_waitcnt lgkmcnt(3)
    v_mfma_f32_32x32x16_bf16 v[56:71], v[176:179], v[24:27], v[56:71]
    ds_read_b128 v[180:183], v7
    ds_read_b64_tr_b16 v[32:33], v10 offset:6144
    s_waitcnt lgkmcnt(3)
    v_mfma_f32_32x32x16_bf16 v[72:87], v[176:179], v[28:31], v[72:87]
    ds_read_b64_tr_b16 v[34:35], v10 offset:6656
    ds_read_b64_tr_b16 v[36:37], v11 offset:6144
    s_waitcnt lgkmcnt(4)
    v_mfma_f32_32x32x16_bf16 v[88:103], v[40:43], v[24:27], v[88:103]
    ds_read_b64_tr_b16 v[38:39], v11 offset:6656
    ds_read_b128 v[44:47], v19
    v_mfma_f32_32x32x16_bf16 v[104:119], v[40:43], v[28:31], v[104:119]
    v_and_b32 v12, 0x33, v0
    v_bfe_u32 v3, v0, 2, 1
    v_lshl_or_b32 v12, v3, 3, v12
    v_bfe_u32 v3, v0, 3, 1
    v_lshl_or_b32 v12, v3, 2, v12
    v_lshlrev_b32 v12, 4, v12
    s_mov_b32 s26, 0x20000
    s_mov_b32 s27, 0x20000
    s_cmp_eq_u32 s6, 0
    s_cbranch_scc1 Lsv_15
    v_and_b32 v12, 0x2f, v0
    v_lshlrev_b32 v12, 4, v12
    v_bfe_u32 v3, v0, 4, 1
    v_lshl_add_u32 v12, v3, 17, v12
    v_add_u32 v12, 1024, v12
    s_mov_b32 s26, 256
    s_mov_b32 s27, 0x3ff00
Lsv_15:
CD_C1A14:
    s_waitcnt lgkmcnt(3)
    v_mfma_f32_32x32x16_bf16 v[56:71], v[180:183], v[32:35], v[56:71]
    v_add_u32 v4, 98304, v4
    v_add_u32 v16, 98304, v16
    v_add_u32 v10, 98304, v10
    v_add_u32 v11, 98304, v11
    s_waitcnt lgkmcnt(0)
    v_mfma_f32_32x32x16_bf16 v[72:87], v[180:183], v[36:39], v[72:87]
    s_barrier
    ds_read_b128 v[184:187], v4
    ds_read_b64_tr_b16 v[24:25], v10 offset:0
    ds_read_b64_tr_b16 v[26:27], v10 offset:512
    v_mfma_f32_32x32x16_bf16 v[88:103], v[44:47], v[32:35], v[88:103]
    ds_read_b64_tr_b16 v[28:29], v11 offset:0
    ds_read_b64_tr_b16 v[30:31], v11 offset:512
    ds_read_b128 v[40:43], v16
    v_mfma_f32_32x32x16_bf16 v[104:119], v[44:47], v[36:39], v[104:119]
    v_add_u32 v5, 98304, v5
    v_add_u32 v6, 98304, v6
    v_add_u32 v7, 98304, v7
    v_add_u32 v17, 98304, v17
    v_add_u32 v18, 98304, v18
    v_add_u32 v19, 98304, v19
CD_C1A15:
    s_waitcnt lgkmcnt(3)
    v_mfma_f32_32x32x16_bf16 v[56:71], v[184:187], v[24:27], v[56:71]
    ds_read_b128 v[188:191], v5
    ds_read_b64_tr_b16 v[32:33], v10 offset:2048
    s_waitcnt lgkmcnt(3)
    v_mfma_f32_32x32x16_bf16 v[72:87], v[184:187], v[28:31], v[72:87]
    ds_read_b64_tr_b16 v[34:35], v10 offset:2560
    ds_read_b64_tr_b16 v[36:37], v11 offset:2048
    s_waitcnt lgkmcnt(4)
    v_mfma_f32_32x32x16_bf16 v[88:103], v[40:43], v[24:27], v[88:103]
    ds_read_b64_tr_b16 v[38:39], v11 offset:2560
    ds_read_b128 v[44:47], v17
    v_mfma_f32_32x32x16_bf16 v[104:119], v[40:43], v[28:31], v[104:119]
    s_lshl_b32 s24, s5, 13
    s_lshl_b32 s25, s16, 7
    s_add_u32 s24, s24, s25
    s_lshl_b32 s25, s6, 16
    s_add_u32 s24, s24, s25
    s_add_u32 s24, s24, 0x1000000
CD_C1A16:
    s_waitcnt lgkmcnt(3)
    v_mfma_f32_32x32x16_bf16 v[56:71], v[188:191], v[32:35], v[56:71]
    ds_read_b128 v[192:195], v6
    ds_read_b64_tr_b16 v[24:25], v10 offset:4096
    s_waitcnt lgkmcnt(3)
    v_mfma_f32_32x32x16_bf16 v[72:87], v[188:191], v[36:39], v[72:87]
    ds_read_b64_tr_b16 v[26:27], v10 offset:4608
    ds_read_b64_tr_b16 v[28:29], v11 offset:4096
    s_waitcnt lgkmcnt(4)
    v_mfma_f32_32x32x16_bf16 v[88:103], v[44:47], v[32:35], v[88:103]
    ds_read_b64_tr_b16 v[30:31], v11 offset:4608
    ds_read_b128 v[40:43], v18
    v_mfma_f32_32x32x16_bf16 v[104:119], v[44:47], v[36:39], v[104:119]
    v_add_u32 v14, 155648, v14
    s_mov_b32 s22, 0x3eb8aa3b
    s_mov_b32 s23, 0x3eb8aa3b
CD_C1A17:
    s_waitcnt lgkmcnt(3)
    v_mfma_f32_32x32x16_bf16 v[56:71], v[192:195], v[24:27], v[56:71]
    ds_read_b128 v[196:199], v7
    ds_read_b64_tr_b16 v[32:33], v10 offset:6144
    s_waitcnt lgkmcnt(3)
    v_mfma_f32_32x32x16_bf16 v[72:87], v[192:195], v[28:31], v[72:87]
    ds_read_b64_tr_b16 v[34:35], v10 offset:6656
    ds_read_b64_tr_b16 v[36:37], v11 offset:6144
    s_waitcnt lgkmcnt(4)
    v_mfma_f32_32x32x16_bf16 v[88:103], v[40:43], v[24:27], v[88:103]
    ds_read_b64_tr_b16 v[38:39], v11 offset:6656
    ds_read_b128 v[44:47], v19
    v_mfma_f32_32x32x16_bf16 v[104:119], v[40:43], v[28:31], v[104:119]
    s_lshl_b32 s21, s15, 1
    s_add_u32 s21, s21, s61
    s_lshl_b32 s21, s21, 12
    s_add_u32 s21, s21, 32768
    v_add_u32 v15, s21, v2
CD_C1A18:
    s_waitcnt lgkmcnt(3)
    v_mfma_f32_32x32x16_bf16 v[56:71], v[196:199], v[32:35], v[56:71]
    v_subrev_u32 v4, 32768, v4
    v_subrev_u32 v16, 32768, v16
    v_subrev_u32 v10, 32768, v10
    v_subrev_u32 v11, 32768, v11
    s_waitcnt lgkmcnt(0)
    v_mfma_f32_32x32x16_bf16 v[72:87], v[196:199], v[36:39], v[72:87]
    s_barrier
    ds_read_b128 v[200:203], v4
    ds_read_b64_tr_b16 v[24:25], v10 offset:0
    ds_read_b64_tr_b16 v[26:27], v10 offset:512
    v_mfma_f32_32x32x16_bf16 v[88:103], v[44:47], v[32:35], v[88:103]
    ds_read_b64_tr_b16 v[28:29], v11 offset:0
    ds_read_b64_tr_b16 v[30:31], v11 offset:512
    ds_read_b128 v[40:43], v16
    v_mfma_f32_32x32x16_bf16 v[104:119], v[44:47], v[36:39], v[104:119]
    v_subrev_u32 v5, 32768, v5
    v_subrev_u32 v6, 32768, v6
    v_subrev_u32 v7, 32768, v7
    v_subrev_u32 v17, 32768, v17
    v_subrev_u32 v18, 32768, v18
    v_subrev_u32 v19, 32768, v19
CD_C1A19:
    s_waitcnt lgkmcnt(3)
    v_mfma_f32_32x32x16_bf16 v[56:71], v[200:203], v[24:27], v[56:71]
    ds_read_b128 v[204:207], v5
    ds_read_b64_tr_b16 v[32:33], v10 offset:2048
    s_waitcnt lgkmcnt(3)
    v_mfma_f32_32x32x16_bf16 v[72:87], v[200:203], v[28:31], v[72:87]
    ds_read_b64_tr_b16 v[34:35], v10 offset:2560
    ds_read_b64_tr_b16 v[36:37], v11 offset:2048
    s_waitcnt lgkmcnt(4)
    v_mfma_f32_32x32x16_bf16 v[88:103], v[40:43], v[24:27], v[88:103]
    ds_read_b64_tr_b16 v[38:39], v11 offset:2560
    ds_read_b128 v[44:47], v17
    v_mfma_f32_32x32x16_bf16 v[104:119], v[40:43], v[28:31], v[104:119]
CD_C1A20:
    s_waitcnt lgkmcnt(3)
    v_mfma_f32_32x32x16_bf16 v[56:71], v[204:207], v[32:35], v[56:71]
    ds_read_b128 v[208:211], v6
    ds_read_b64_tr_b16 v[24:25], v10 offset:4096
    s_waitcnt lgkmcnt(3)
    v_mfma_f32_32x32x16_bf16 v[72:87], v[204:207], v[36:39], v[72:87]
    ds_read_b64_tr_b16 v[26:27], v10 offset:4608
    ds_read_b64_tr_b16 v[28:29], v11 offset:4096
    s_waitcnt lgkmcnt(4)
    v_mfma_f32_32x32x16_bf16 v[88:103], v[44:47], v[32:35], v[88:103]
    ds_read_b64_tr_b16 v[30:31], v11 offset:4608
    ds_read_b128 v[40:43], v18
    v_mfma_f32_32x32x16_bf16 v[104:119], v[44:47], v[36:39], v[104:119]
CD_C1A21:
    s_waitcnt lgkmcnt(3)
    v_mfma_f32_32x32x16_bf16 v[56:71], v[208:211], v[24:27], v[56:71]
    ds_read_b128 v[212:215], v7
    ds_read_b64_tr_b16 v[32:33], v10 offset:6144
    s_waitcnt lgkmcnt(3)
    v_mfma_f32_32x32x16_bf16 v[72:87], v[208:211], v[28:31], v[72:87]
    ds_read_b64_tr_b16 v[34:35], v10 offset:6656
    ds_read_b64_tr_b16 v[36:37], v11 offset:6144
    s_waitcnt lgkmcnt(4)
    v_mfma_f32_32x32x16_bf16 v[88:103], v[40:43], v[24:27], v[88:103]
    ds_read_b64_tr_b16 v[38:39], v11 offset:6656
    ds_read_b128 v[44:47], v19
    v_mfma_f32_32x32x16_bf16 v[104:119], v[40:43], v[28:31], v[104:119]
CD_C1A22:
    s_waitcnt lgkmcnt(3)
    v_mfma_f32_32x32x16_bf16 v[56:71], v[212:215], v[32:35], v[56:71]
    v_subrev_u32 v4, 32768, v4
    v_subrev_u32 v16, 32768, v16
    v_subrev_u32 v10, 32768, v10
    v_subrev_u32 v11, 32768, v11
    s_waitcnt lgkmcnt(0)
    v_mfma_f32_32x32x16_bf16 v[72:87], v[212:215], v[36:39], v[72:87]
    s_barrier
    ds_read_b128 v[216:219], v4
    ds_read_b64_tr_b16 v[24:25], v10 offset:0
    ds_read_b64_tr_b16 v[26:27], v10 offset:512
    v_mfma_f32_32x32x16_bf16 v[88:103], v[44:47], v[32:35], v[88:103]
    ds_read_b64_tr_b16 v[28:29], v11 offset:0
    ds_read_b64_tr_b16 v[30:31], v11 offset:512
    ds_read_b128 v[40:43], v16
    v_mfma_f32_32x32x16_bf16 v[104:119], v[44:47], v[36:39], v[104:119]
    v_subrev_u32 v5, 32768, v5
    v_subrev_u32 v6, 32768, v6
    v_subrev_u32 v7, 32768, v7
    v_subrev_u32 v17, 32768, v17
    v_subrev_u32 v18, 32768, v18
    v_subrev_u32 v19, 32768, v19
CD_C1A23:
    s_waitcnt lgkmcnt(3)
    v_mfma_f32_32x32x16_bf16 v[56:71], v[216:219], v[24:27], v[56:71]
    ds_read_b128 v[220:223], v5
    ds_read_b64_tr_b16 v[32:33], v10 offset:2048
    s_waitcnt lgkmcnt(3)
    v_mfma_f32_32x32x16_bf16 v[72:87], v[216:219], v[28:31], v[72:87]
    ds_read_b64_tr_b16 v[34:35], v10 offset:2560
    ds_read_b64_tr_b16 v[36:37], v11 offset:2048
    s_waitcnt lgkmcnt(4)
    v_mfma_f32_32x32x16_bf16 v[88:103], v[40:43], v[24:27], v[88:103]
    ds_read_b64_tr_b16 v[38:39], v11 offset:2560
    ds_read_b128 v[44:47], v17
    v_mfma_f32_32x32x16_bf16 v[104:119], v[40:43], v[28:31], v[104:119]
CD_C1A24:
    s_waitcnt lgkmcnt(3)
    v_mfma_f32_32x32x16_bf16 v[56:71], v[220:223], v[32:35], v[56:71]
    ds_read_b128 v[224:227], v6
    ds_read_b64_tr_b16 v[24:25], v10 offset:4096
    s_waitcnt lgkmcnt(3)
    v_mfma_f32_32x32x16_bf16 v[72:87], v[220:223], v[36:39], v[72:87]
    ds_read_b64_tr_b16 v[26:27], v10 offset:4608
    ds_read_b64_tr_b16 v[28:29], v11 offset:4096
    s_waitcnt lgkmcnt(4)
    v_mfma_f32_32x32x16_bf16 v[88:103], v[44:47], v[32:35], v[88:103]
    ds_read_b64_tr_b16 v[30:31], v11 offset:4608
    ds_read_b128 v[40:43], v18
    v_mfma_f32_32x32x16_bf16 v[104:119], v[44:47], v[36:39], v[104:119]
CD_C1A25:
    s_waitcnt lgkmcnt(3)
    v_mfma_f32_32x32x16_bf16 v[56:71], v[224:227], v[24:27], v[56:71]
    ds_read_b128 v[228:231], v7
    ds_read_b64_tr_b16 v[32:33], v10 offset:6144
    s_waitcnt lgkmcnt(3)
    v_mfma_f32_32x32x16_bf16 v[72:87], v[224:227], v[28:31], v[72:87]
    ds_read_b64_tr_b16 v[34:35], v10 offset:6656
    ds_read_b64_tr_b16 v[36:37], v11 offset:6144
    s_waitcnt lgkmcnt(4)
    v_mfma_f32_32x32x16_bf16 v[88:103], v[40:43], v[24:27], v[88:103]
    ds_read_b64_tr_b16 v[38:39], v11 offset:6656
    ds_read_b128 v[44:47], v19
    v_mfma_f32_32x32x16_bf16 v[104:119], v[40:43], v[28:31], v[104:119]
CD_C1A26:
    s_waitcnt lgkmcnt(3)
    v_mfma_f32_32x32x16_bf16 v[56:71], v[228:231], v[32:35], v[56:71]
    v_subrev_u32 v4, 32768, v4
    v_subrev_u32 v16, 32768, v16
    v_subrev_u32 v10, 32768, v10
    v_subrev_u32 v11, 32768, v11
    s_waitcnt lgkmcnt(0)
    v_mfma_f32_32x32x16_bf16 v[72:87], v[228:231], v[36:39], v[72:87]
    s_barrier
    ds_read_b128 v[232:235], v4
    ds_read_b64_tr_b16 v[24:25], v10 offset:0
    ds_read_b64_tr_b16 v[26:27], v10 offset:512
    v_mfma_f32_32x32x16_bf16 v[88:103], v[44:47], v[32:35], v[88:103]
    ds_read_b64_tr_b16 v[28:29], v11 offset:0
    ds_read_b64_tr_b16 v[30:31], v11 offset:512
    ds_read_b128 v[40:43], v16
    v_mfma_f32_32x32x16_bf16 v[104:119], v[44:47], v[36:39], v[104:119]
    v_subrev_u32 v5, 32768, v5
    v_subrev_u32 v6, 32768, v6
    v_subrev_u32 v7, 32768, v7
    v_subrev_u32 v17, 32768, v17
    v_subrev_u32 v18, 32768, v18
    v_subrev_u32 v19, 32768, v19
CD_C1A27:
    s_waitcnt lgkmcnt(3)
    v_mfma_f32_32x32x16_bf16 v[56:71], v[232:235], v[24:27], v[56:71]
    ds_read_b128 v[236:239], v5
    ds_read_b64_tr_b16 v[32:33], v10 offset:2048
    s_waitcnt lgkmcnt(3)
    v_mfma_f32_32x32x16_bf16 v[72:87], v[232:235], v[28:31], v[72:87]
    ds_read_b64_tr_b16 v[34:35], v10 offset:2560
    ds_read_b64_tr_b16 v[36:37], v11 offset:2048
    s_waitcnt lgkmcnt(4)
    v_mfma_f32_32x32x16_bf16 v[88:103], v[40:43], v[24:27], v[88:103]
    ds_read_b64_tr_b16 v[38:39], v11 offset:2560
    ds_read_b128 v[44:47], v17
    v_mfma_f32_32x32x16_bf16 v[104:119], v[40:43], v[28:31], v[104:119]
CD_C1A28:
    s_waitcnt lgkmcnt(3)
    v_mfma_f32_32x32x16_bf16 v[56:71], v[236:239], v[32:35], v[56:71]
    ds_read_b128 v[240:243], v6
    ds_read_b64_tr_b16 v[24:25], v10 offset:4096
    s_waitcnt lgkmcnt(3)
    v_mfma_f32_32x32x16_bf16 v[72:87], v[236:239], v[36:39], v[72:87]
    ds_read_b64_tr_b16 v[26:27], v10 offset:4608
    ds_read_b64_tr_b16 v[28:29], v11 offset:4096
    s_waitcnt lgkmcnt(4)
    v_mfma_f32_32x32x16_bf16 v[88:103], v[44:47], v[32:35], v[88:103]
    ds_read_b64_tr_b16 v[30:31], v11 offset:4608
    ds_read_b128 v[40:43], v18
    v_mfma_f32_32x32x16_bf16 v[104:119], v[44:47], v[36:39], v[104:119]
CD_C1A29:
    s_waitcnt lgkmcnt(3)
    v_mfma_f32_32x32x16_bf16 v[56:71], v[240:243], v[24:27], v[56:71]
    ds_read_b128 v[244:247], v7
    ds_read_b64_tr_b16 v[32:33], v10 offset:6144
    s_waitcnt lgkmcnt(3)
    v_mfma_f32_32x32x16_bf16 v[72:87], v[240:243], v[28:31], v[72:87]
    ds_read_b64_tr_b16 v[34:35], v10 offset:6656
    ds_read_b64_tr_b16 v[36:37], v11 offset:6144
    s_waitcnt lgkmcnt(4)
    v_mfma_f32_32x32x16_bf16 v[88:103], v[40:43], v[24:27], v[88:103]
    ds_read_b64_tr_b16 v[38:39], v11 offset:6656
    ds_read_b128 v[44:47], v19
    v_mfma_f32_32x32x16_bf16 v[104:119], v[40:43], v[28:31], v[104:119]
CD_C1A30:
    s_waitcnt lgkmcnt(3)
    v_mfma_f32_32x32x16_bf16 v[56:71], v[244:247], v[32:35], v[56:71]
    s_waitcnt lgkmcnt(1)
    v_mfma_f32_32x32x16_bf16 v[72:87], v[244:247], v[36:39], v[72:87]
    s_waitcnt lgkmcnt(0)
    v_mfma_f32_32x32x16_bf16 v[88:103], v[44:47], v[32:35], v[88:103]
    v_mfma_f32_32x32x16_bf16 v[104:119], v[44:47], v[36:39], v[104:119]
CD_C1A31:
    s_branch SK_C1A31
.p2align 12
PG_C1A31:
    s_setpc_b64 s[100:101]
SK_C1A31:
    v_xor_b32 v16, 0x2000, v15
    s_nop 7
    s_nop 1
    v_cvt_pk_bf16_f32 v56, v56, v57
    v_cvt_pk_bf16_f32 v57, v58, v59
    v_cvt_pk_bf16_f32 v58, v60, v61
    v_cvt_pk_bf16_f32 v59, v62, v63
    ds_write_b128 v15, v[56:59] offset:0
    v_cvt_pk_bf16_f32 v60, v64, v65
    v_cvt_pk_bf16_f32 v61, v66, v67
    v_cvt_pk_bf16_f32 v62, v68, v69
    v_cvt_pk_bf16_f32 v63, v70, v71
    ds_write_b128 v15, v[60:63] offset:1024
    v_cvt_pk_bf16_f32 v72, v72, v73
    v_cvt_pk_bf16_f32 v73, v74, v75
    v_cvt_pk_bf16_f32 v74, v76, v77
    v_cvt_pk_bf16_f32 v75, v78, v79
    ds_write_b128 v15, v[72:75] offset:2048
    v_cvt_pk_bf16_f32 v76, v80, v81
    v_cvt_pk_bf16_f32 v77, v82, v83
    v_cvt_pk_bf16_f32 v78, v84, v85
    v_cvt_pk_bf16_f32 v79, v86, v87
    ds_write_b128 v15, v[76:79] offset:3072
    v_cvt_pk_bf16_f32 v88, v88, v89
    v_cvt_pk_bf16_f32 v89, v90, v91
    v_cvt_pk_bf16_f32 v90, v92, v93
    v_cvt_pk_bf16_f32 v91, v94, v95
    ds_write_b128 v16, v[88:91] offset:0
    v_cvt_pk_bf16_f32 v92, v96, v97
    v_cvt_pk_bf16_f32 v93, v98, v99
    v_cvt_pk_bf16_f32 v94, v100, v101
    v_cvt_pk_bf16_f32 v95, v102, v103
    ds_write_b128 v16, v[92:95] offset:1024
    v_cvt_pk_bf16_f32 v104, v104, v105
    v_cvt_pk_bf16_f32 v105, v106, v107
    v_cvt_pk_bf16_f32 v106, v108, v109
    v_cvt_pk_bf16_f32 v107, v110, v111
    ds_write_b128 v16, v[104:107] offset:2048
    v_cvt_pk_bf16_f32 v108, v112, v113
    v_cvt_pk_bf16_f32 v109, v114, v115
    v_cvt_pk_bf16_f32 v110, v116, v117
    v_cvt_pk_bf16_f32 v111, v118, v119
    ds_write_b128 v16, v[108:111] offset:3072
    s_mov_b64 exec, 1
    buffer_load_dwordx2 v[20:21], v13, s[52:55], 0 offen sc1
    s_mov_b64 exec, -1
    s_waitcnt lgkmcnt(0)
    s_barrier
L_B1:
    v_add_u32 v10, 131072, v8
    v_add_u32 v11, 131072, v9
    ds_read_b64_tr_b16 v[24:25], v10 offset:0
    ds_read_b64_tr_b16 v[26:27], v10 offset:512
    ds_read_b64_tr_b16 v[28:29], v11 offset:0
    ds_read_b64_tr_b16 v[30:31], v11 offset:512
    ds_read_b128 v[88:91], v14 offset:0
    ds_read_b64_tr_b16 v[32:33], v10 offset:2048
    ds_read_b64_tr_b16 v[34:35], v10 offset:2560
    ds_read_b64_tr_b16 v[36:37], v11 offset:2048
    ds_read_b64_tr_b16 v[38:39], v11 offset:2560
    ds_read_b128 v[92:95], v14 offset:32
    ds_read_b64_tr_b16 v[40:41], v10 offset:4096
    ds_read_b64_tr_b16 v[42:43], v10 offset:4608
    ds_read_b64_tr_b16 v[44:45], v11 offset:4096
    ds_read_b64_tr_b16 v[46:47], v11 offset:4608
    ds_read_b128 v[96:99], v14 offset:64
    s_waitcnt lgkmcnt(10)
    v_mfma_f32_32x32x16_bf16 v[56:71], v[120:123], v[24:27], 0
    ds_read_b64_tr_b16 v[48:49], v10 offset:6144
    ds_read_b64_tr_b16 v[50:51], v10 offset:6656
    ds_read_b64_tr_b16 v[52:53], v11 offset:6144
    v_bfe_u32 v16, v0, 2, 2
    v_lshrrev_b32 v17, 5, v0
    v_mfma_f32_32x32x16_bf16 v[72:87], v[120:123], v[28:31], 0
    ds_read_b64_tr_b16 v[54:55], v11 offset:6656
    ds_read_b128 v[100:103], v14 offset:96
    v_lshl_add_u32 v16, v17, 2, v16
    v_lshlrev_b32 v16, 7, v16
    v_mfma_f32_32x32x16_bf16 v[104:119], v[88:91], v[120:123], 0
    v_bfe_u32 v17, v0, 4, 1
    v_lshlrev_b32 v17, 1, v17
CD_C1B0:
    s_waitcnt lgkmcnt(10)
    v_mfma_f32_32x32x16_bf16 v[56:71], v[124:127], v[32:35], v[56:71]
    ds_read_b64_tr_b16 v[24:25], v10 offset:8192
    ds_read_b64_tr_b16 v[26:27], v10 offset:8704
    ds_read_b64_tr_b16 v[28:29], v11 offset:8192
    v_bfe_u32 v18, v0, 1, 1
    v_or_b32 v17, v17, v18
    v_mfma_f32_32x32x16_bf16 v[72:87], v[124:127], v[36:39], v[72:87]
    ds_read_b64_tr_b16 v[30:31], v11 offset:8704
    ds_read_b128 v[88:91], v14 offset:128
    v_bfe_u32 v18, v0, 3, 1
    v_lshl_or_b32 v17, v18, 2, v17
    v_mfma_f32_32x32x16_bf16 v[104:119], v[92:95], v[124:127], v[104:119]
    v_lshl_add_u32 v16, v17, 4, v16
    v_and_b32 v18, 1, v0
CD_C1B1:
    s_waitcnt lgkmcnt(10)
    v_mfma_f32_32x32x16_bf16 v[56:71], v[128:131], v[40:43], v[56:71]
    ds_read_b64_tr_b16 v[32:33], v10 offset:10240
    ds_read_b64_tr_b16 v[34:35], v10 offset:10752
    ds_read_b64_tr_b16 v[36:37], v11 offset:10240
    v_lshl_add_u32 v16, v18, 3, v16
    s_lshr_b32 s58, s3, 1
    s_lshl_b32 s58, s58, 14
    v_add_u32 v16, s58, v16
    v_mfma_f32_32x32x16_bf16 v[72:87], v[128:131], v[44:47], v[72:87]
    ds_read_b64_tr_b16 v[38:39], v11 offset:10752
    ds_read_b128 v[92:95], v14 offset:160
    v_xor_b32 v17, 64, v16
    v_add_u32 v18, 0x10000, v16
    v_mfma_f32_32x32x16_bf16 v[104:119], v[96:99], v[128:131], v[104:119]
    v_add_u32 v19, 0x10000, v17
    v_lshrrev_b32 v3, 5, v0
    v_mul_u32_u24 v3, 40, v3
    v_sub_u32 v3, v0, v3
CD_C1B2:
    s_waitcnt lgkmcnt(10)
    v_mfma_f32_32x32x16_bf16 v[56:71], v[132:135], v[48:51], v[56:71]
    ds_read_b64_tr_b16 v[40:41], v10 offset:12288
    ds_read_b64_tr_b16 v[42:43], v10 offset:12800
    ds_read_b64_tr_b16 v[44:45], v11 offset:12288
    v_cmp_le_i32 s[64:65], 0, v3
    v_cmp_le_i32 s[66:67], 1, v3
    v_mfma_f32_32x32x16_bf16 v[72:87], v[132:135], v[52:55], v[72:87]
    ds_read_b64_tr_b16 v[46:47], v11 offset:12800
    ds_read_b128 v[96:99], v14 offset:192
    v_cmp_le_i32 s[68:69], 2, v3
    v_cmp_le_i32 s[70:71], 3, v3
    v_mfma_f32_32x32x16_bf16 v[104:119], v[100:103], v[132:135], v[104:119]
    v_cmp_le_i32 s[72:73], 4, v3
    v_cmp_le_i32 s[74:75], 5, v3
CD_C1B3:
    s_waitcnt lgkmcnt(10)
    v_mfma_f32_32x32x16_bf16 v[56:71], v[136:139], v[24:27], v[56:71]
    ds_read_b64_tr_b16 v[48:49], v10 offset:14336
    ds_read_b64_tr_b16 v[50:51], v10 offset:14848
    ds_read_b64_tr_b16 v[52:53], v11 offset:14336
    v_cmp_le_i32 s[76:77], 6, v3
    v_cmp_le_i32 s[78:79], 7, v3
    v_mfma_f32_32x32x16_bf16 v[72:87], v[136:139], v[28:31], v[72:87]
    ds_read_b64_tr_b16 v[54:55], v11 offset:14848
    ds_read_b128 v[100:103], v14 offset:224
    v_cmp_le_i32 s[80:81], 16, v3
    v_cmp_le_i32 s[82:83], 17, v3
    v_mfma_f32_32x32x16_bf16 v[104:119], v[88:91], v[136:139], v[104:119]
    v_cmp_le_i32 s[84:85], 18, v3
    v_cmp_le_i32 s[86:87], 19, v3
CD_C1B4:
    s_waitcnt lgkmcnt(10)
    s_barrier
    v_mfma_f32_32x32x16_bf16 v[56:71], v[140:143], v[32:35], v[56:71]
    ds_read_b64_tr_b16 v[24:25], v10 offset:16384
    ds_read_b64_tr_b16 v[26:27], v10 offset:16896
    ds_read_b64_tr_b16 v[28:29], v11 offset:16384
    v_cmp_le_i32 s[88:89], 20, v3
    v_cmp_le_i32 s[90:91], 21, v3
    v_mfma_f32_32x32x16_bf16 v[72:87], v[140:143], v[36:39], v[72:87]
    ds_read_b64_tr_b16 v[30:31], v11 offset:16896
    ds_read_b128 v[88:91], v14 offset:256
    v_cmp_le_i32 s[92:93], 22, v3
    v_cmp_le_i32 s[94:95], 23, v3
    v_mfma_f32_32x32x16_bf16 v[104:119], v[92:95], v[140:143], v[104:119]
    v_and_b32 v3, 0x1b, v0
    v_cmp_eq_u32 vcc, 16, v3
    v_mov_b32 v3, 0x3f803f80
    s_mov_b32 s56, 0xffff
    s_mov_b32 s57, 0xffff
    v_cndmask_b32 v120, 0, v3, vcc
    v_cndmask_b32 v121, 0, v3, vcc
    v_mov_b64 v[122:123], v[120:121]
CD_C1B5:
    s_waitcnt lgkmcnt(10)
    v_mfma_f32_32x32x16_bf16 v[56:71], v[144:147], v[40:43], v[56:71]
    ds_read_b64_tr_b16 v[32:33], v10 offset:18432
    ds_read_b64_tr_b16 v[34:35], v10 offset:18944
    ds_read_b64_tr_b16 v[36:37], v11 offset:18432
    v_mov_b64 v[124:125], v[120:121]
    v_mov_b64 v[126:127], v[120:121]
    v_mfma_f32_32x32x16_bf16 v[72:87], v[144:147], v[44:47], v[72:87]
    ds_read_b64_tr_b16 v[38:39], v11 offset:18944
    ds_read_b128 v[92:95], v14 offset:288
    v_mov_b64 v[128:129], v[120:121]
    v_mov_b64 v[130:131], v[120:121]
    v_mfma_f32_32x32x16_bf16 v[104:119], v[96:99], v[144:147], v[104:119]
    v_mov_b64 v[132:133], v[120:121]
    v_mov_b64 v[134:135], v[120:121]
CD_C1B6:
    s_waitcnt lgkmcnt(10)
    v_mfma_f32_32x32x16_bf16 v[56:71], v[148:151], v[48:51], v[56:71]
    ds_read_b64_tr_b16 v[40:41], v10 offset:20480
    ds_read_b64_tr_b16 v[42:43], v10 offset:20992
    ds_read_b64_tr_b16 v[44:45], v11 offset:20480
    v_mfma_f32_32x32x16_bf16 v[72:87], v[148:151], v[52:55], v[72:87]
    ds_read_b64_tr_b16 v[46:47], v11 offset:20992
    ds_read_b128 v[96:99], v14 offset:320
    v_mfma_f32_32x32x16_bf16 v[104:119], v[100:103], v[148:151], v[104:119]
CD_C1B7:
    s_waitcnt lgkmcnt(10)
    v_mfma_f32_32x32x16_bf16 v[56:71], v[152:155], v[24:27], v[56:71]
    ds_read_b64_tr_b16 v[48:49], v10 offset:22528
    ds_read_b64_tr_b16 v[50:51], v10 offset:23040
    ds_read_b64_tr_b16 v[52:53], v11 offset:22528
    v_mfma_f32_32x32x16_bf16 v[72:87], v[152:155], v[28:31], v[72:87]
    ds_read_b64_tr_b16 v[54:55], v11 offset:23040
    ds_read_b128 v[100:103], v14 offset:352
    v_mfma_f32_32x32x16_bf16 v[104:119], v[88:91], v[152:155], v[104:119]
CD_C1B8:
    s_waitcnt lgkmcnt(10)
    v_mfma_f32_32x32x16_bf16 v[56:71], v[156:159], v[32:35], v[56:71]
    v_add_u32 v10, 98304, v8
    v_add_u32 v11, 98304, v9
    ds_read_b64_tr_b16 v[24:25], v10 offset:0
    ds_read_b64_tr_b16 v[26:27], v10 offset:512
    v_mfma_f32_32x32x16_bf16 v[72:87], v[156:159], v[36:39], v[72:87]
    ds_read_b64_tr_b16 v[28:29], v11 offset:0
    ds_read_b64_tr_b16 v[30:31], v11 offset:512
    ds_read_b128 v[88:91], v14 offset:384
    v_mfma_f32_32x32x16_bf16 v[104:119], v[92:95], v[156:159], v[104:119]
CD_C1B9:
    s_waitcnt lgkmcnt(10)
    v_mfma_f32_32x32x16_bf16 v[56:71], v[160:163], v[40:43], v[56:71]
    ds_read_b64_tr_b16 v[32:33], v10 offset:2048
    ds_read_b64_tr_b16 v[34:35], v10 offset:2560
    ds_read_b64_tr_b16 v[36:37], v11 offset:2048
    v_mov_b32 v157, 0xff800000
    v_cndmask_b32 v136, v157, 0, s[64:65]
    v_mfma_f32_32x32x16_bf16 v[72:87], v[160:163], v[44:47], v[72:87]
    ds_read_b64_tr_b16 v[38:39], v11 offset:2560
    ds_read_b128 v[92:95], v14 offset:416
    v_cndmask_b32 v137, v157, 0, s[66:67]
    v_cndmask_b32 v138, v157, 0, s[68:69]
    v_mfma_f32_32x32x16_bf16 v[104:119], v[96:99], v[160:163], v[104:119]
    v_cndmask_b32 v139, v157, 0, s[70:71]
    v_cndmask_b32 v140, v157, 0, s[72:73]
CD_C1B10:
    s_waitcnt lgkmcnt(10)
    v_mfma_f32_32x32x16_bf16 v[56:71], v[164:167], v[48:51], v[56:71]
    ds_read_b64_tr_b16 v[40:41], v10 offset:4096
    ds_read_b64_tr_b16 v[42:43], v10 offset:4608
    ds_read_b64_tr_b16 v[44:45], v11 offset:4096
    v_cndmask_b32 v141, v157, 0, s[74:75]
    v_cndmask_b32 v142, v157, 0, s[76:77]
    v_mfma_f32_32x32x16_bf16 v[72:87], v[164:167], v[52:55], v[72:87]
    ds_read_b64_tr_b16 v[46:47], v11 offset:4608
    ds_read_b128 v[96:99], v14 offset:448
    v_cndmask_b32 v143, v157, 0, s[78:79]
    v_cndmask_b32 v144, v157, 0, s[80:81]
    v_mfma_f32_32x32x16_bf16 v[104:119], v[100:103], v[164:167], v[104:119]
    v_cndmask_b32 v145, v157, 0, s[82:83]
    v_cndmask_b32 v146, v157, 0, s[84:85]
CD_C1B11:
    s_waitcnt lgkmcnt(10)
    v_mfma_f32_32x32x16_bf16 v[56:71], v[168:171], v[24:27], v[56:71]
    ds_read_b64_tr_b16 v[48:49], v10 offset:6144
    ds_read_b64_tr_b16 v[50:51], v10 offset:6656
    ds_read_b64_tr_b16 v[52:53], v11 offset:6144
    v_cndmask_b32 v147, v157, 0, s[86:87]
    v_cndmask_b32 v148, v157, 0, s[88:89]
    v_mfma_f32_32x32x16_bf16 v[72:87], v[168:171], v[28:31], v[72:87]
    ds_read_b64_tr_b16 v[54:55], v11 offset:6656
    ds_read_b128 v[100:103], v14 offset:480
    v_cndmask_b32 v149, v157, 0, s[90:91]
    v_cndmask_b32 v150, v157, 0, s[92:93]
    v_mfma_f32_32x32x16_bf16 v[104:119], v[88:91], v[168:171], v[104:119]
    v_cndmask_b32 v151, v157, 0, s[94:95]
    v_mov_b32 v152, 0xdddddddd
CD_C1B12:
    s_waitcnt lgkmcnt(10)
    v_mfma_f32_32x32x16_bf16 v[56:71], v[172:175], v[32:35], v[56:71]
    ds_read_b64_tr_b16 v[24:25], v10 offset:8192
    ds_read_b64_tr_b16 v[26:27], v10 offset:8704
    v_mov_b32 v153, v2
    s_lshl_b32 s58, s3, 11
    s_add_u32 s58, s58, 131072
    v_add_u32 v154, s58, v2
    v_mfma_f32_32x32x16_bf16 v[72:87], v[172:175], v[36:39], v[72:87]
    ds_read_b64_tr_b16 v[28:29], v11 offset:8192
    ds_read_b64_tr_b16 v[30:31], v11 offset:8704
    s_lshl_b32 s58, s3, 10
    s_add_u32 s58, s58, 81920
    v_add_u32 v156, s58, v2
    s_lshl_b32 s58, s9, 1
    v_add_u32 v158, s58, v0
    v_mfma_f32_32x32x16_bf16 v[104:119], v[92:95], v[172:175], v[104:119]
    v_and_b32 v158, 15, v158
    s_and_b32 s58, s3, 1
    s_lshl_b32 s58, s58, 6
    s_lshr_b32 s59, s3, 1
    s_add_u32 s58, s58, s59
    v_lshl_add_u32 v158, v158, 2, s58
CD_C1B13:
    s_waitcnt lgkmcnt(9)
    v_mfma_f32_32x32x16_bf16 v[56:71], v[176:179], v[40:43], v[56:71]
    ds_read_b64_tr_b16 v[32:33], v10 offset:10240
    ds_read_b64_tr_b16 v[34:35], v10 offset:10752
    v_and_b32 v159, 1, v0
    s_lshl_b32 s58, s9, 3
    s_lshl_b32 s59, s3, 1
    s_add_u32 s58, s58, s59
    s_sub_i32 s58, s58, 8
    s_max_i32 s58, s58, 0
    s_add_u32 s58, s58, 1024
    v_add_u32 v159, s58, v159
    v_mfma_f32_32x32x16_bf16 v[72:87], v[176:179], v[44:47], v[72:87]
    ds_read_b64_tr_b16 v[36:37], v11 offset:10240
    ds_read_b64_tr_b16 v[38:39], v11 offset:10752
    v_bfe_u32 v3, v0, 1, 1
    v_lshl_add_u32 v159, v3, 6, v159
    v_mfma_f32_32x32x16_bf16 v[104:119], v[96:99], v[176:179], v[104:119]
    v_cmp_gt_u32 vcc, 16, v0
    v_and_b32 v3, 1, v0
    v_mul_u32_u24 v3, 1088, v3
    v_cndmask_b32 v158, v159, v158, vcc
    v_bfe_u32 v159, v0, 1, 1
    v_lshl_add_u32 v3, v159, 6, v3
CD_C1B14:
    s_waitcnt lgkmcnt(8)
    v_mfma_f32_32x32x16_bf16 v[56:71], v[180:183], v[48:51], v[56:71]
    ds_read_b64_tr_b16 v[40:41], v10 offset:12288
    ds_read_b64_tr_b16 v[42:43], v10 offset:12800
    v_cmp_le_u32 vcc, 20, v0
    s_add_u32 s58, s10, 1024
    v_add_u32 v159, s58, v3
    s_nop 0
    v_cndmask_b32 v158, v158, v159, vcc
    v_mfma_f32_32x32x16_bf16 v[72:87], v[180:183], v[52:55], v[72:87]
    ds_read_b64_tr_b16 v[44:45], v11 offset:12288
    ds_read_b64_tr_b16 v[46:47], v11 offset:12800
    v_mfma_f32_32x32x16_bf16 v[104:119], v[100:103], v[180:183], v[104:119]
CD_C1B15:
    s_waitcnt lgkmcnt(8)
    v_mfma_f32_32x32x16_bf16 v[56:71], v[184:187], v[24:27], v[56:71]
    ds_read_b64_tr_b16 v[48:49], v10 offset:14336
    ds_read_b64_tr_b16 v[50:51], v10 offset:14848
    v_mfma_f32_32x32x16_bf16 v[72:87], v[184:187], v[28:31], v[72:87]
    ds_read_b64_tr_b16 v[52:53], v11 offset:14336
    ds_read_b64_tr_b16 v[54:55], v11 offset:14848
CD_C1B16:
    s_waitcnt lgkmcnt(8)
    v_mfma_f32_32x32x16_bf16 v[56:71], v[188:191], v[32:35], v[56:71]
    ds_read_b64_tr_b16 v[24:25], v10 offset:16384
    ds_read_b64_tr_b16 v[26:27], v10 offset:16896
    v_mfma_f32_32x32x16_bf16 v[72:87], v[188:191], v[36:39], v[72:87]
    ds_read_b64_tr_b16 v[28:29], v11 offset:16384
    ds_read_b64_tr_b16 v[30:31], v11 offset:16896
CD_C1B17:
    s_waitcnt lgkmcnt(8)
    v_mfma_f32_32x32x16_bf16 v[56:71], v[192:195], v[40:43], v[56:71]
    ds_read_b64_tr_b16 v[32:33], v10 offset:18432
    ds_read_b64_tr_b16 v[34:35], v10 offset:18944
    v_mov_b64 v[160:161], 0
    v_mov_b64 v[162:163], 0
    v_mfma_f32_32x32x16_bf16 v[72:87], v[192:195], v[44:47], v[72:87]
    ds_read_b64_tr_b16 v[36:37], v11 offset:18432
    ds_read_b64_tr_b16 v[38:39], v11 offset:18944
    v_mov_b64 v[164:165], 0
    v_mov_b64 v[166:167], 0
CD_C1B18:
    s_waitcnt lgkmcnt(8)
    v_mfma_f32_32x32x16_bf16 v[56:71], v[196:199], v[48:51], v[56:71]
    ds_read_b64_tr_b16 v[40:41], v10 offset:20480
    ds_read_b64_tr_b16 v[42:43], v10 offset:20992
    v_mov_b64 v[168:169], 0
    v_mov_b64 v[170:171], 0
    v_mfma_f32_32x32x16_bf16 v[72:87], v[196:199], v[52:55], v[72:87]
    ds_read_b64_tr_b16 v[44:45], v11 offset:20480
    ds_read_b64_tr_b16 v[46:47], v11 offset:20992
    v_mov_b64 v[172:173], 0
    v_mov_b64 v[174:175], 0
CD_C1B19:
    s_waitcnt lgkmcnt(8)
    v_mfma_f32_32x32x16_bf16 v[56:71], v[200:203], v[24:27], v[56:71]
    ds_read_b64_tr_b16 v[48:49], v10 offset:22528
    ds_read_b64_tr_b16 v[50:51], v10 offset:23040
    v_mov_b64 v[176:177], 0
    v_mov_b64 v[178:179], 0
    v_mfma_f32_32x32x16_bf16 v[72:87], v[200:203], v[28:31], v[72:87]
    ds_read_b64_tr_b16 v[52:53], v11 offset:22528
    ds_read_b64_tr_b16 v[54:55], v11 offset:23040
    v_mov_b64 v[180:181], 0
    v_mov_b64 v[182:183], 0
CD_C1B20:
    s_waitcnt lgkmcnt(8)
    v_mfma_f32_32x32x16_bf16 v[56:71], v[204:207], v[32:35], v[56:71]
    ds_read_b64_tr_b16 v[24:25], v10 offset:24576
    ds_read_b64_tr_b16 v[26:27], v10 offset:25088
    v_mov_b64 v[184:185], 0
    v_mov_b64 v[186:187], 0
    v_mfma_f32_32x32x16_bf16 v[72:87], v[204:207], v[36:39], v[72:87]
    ds_read_b64_tr_b16 v[28:29], v11 offset:24576
    ds_read_b64_tr_b16 v[30:31], v11 offset:25088
    v_mov_b64 v[188:189], 0
    v_mov_b64 v[190:191], 0
CD_C1B21:
    s_waitcnt lgkmcnt(8)
    v_mfma_f32_32x32x16_bf16 v[56:71], v[208:211], v[40:43], v[56:71]
    ds_read_b64_tr_b16 v[32:33], v10 offset:26624
    ds_read_b64_tr_b16 v[34:35], v10 offset:27136
    v_lshrrev_b32 v159, 3, v0
    v_bfe_u32 v3, v0, 4, 1
    v_lshlrev_b32 v3, 2, v3
    v_xor_b32 v3, v3, v0
    v_mfma_f32_32x32x16_bf16 v[72:87], v[208:211], v[44:47], v[72:87]
    ds_read_b64_tr_b16 v[36:37], v11 offset:26624
    ds_read_b64_tr_b16 v[38:39], v11 offset:27136
    v_and_b32 v3, 7, v3
    v_lshlrev_b32 v3, 4, v3
CD_C1B22:
    s_waitcnt lgkmcnt(8)
    v_mfma_f32_32x32x16_bf16 v[56:71], v[212:215], v[48:51], v[56:71]
    ds_read_b64_tr_b16 v[40:41], v10 offset:28672
    ds_read_b64_tr_b16 v[42:43], v10 offset:29184
    v_mfma_f32_32x32x16_bf16 v[72:87], v[212:215], v[52:55], v[72:87]
    ds_read_b64_tr_b16 v[44:45], v11 offset:28672
    ds_read_b64_tr_b16 v[46:47], v11 offset:29184
CD_C1B23:
    s_waitcnt lgkmcnt(8)
    v_mfma_f32_32x32x16_bf16 v[56:71], v[216:219], v[24:27], v[56:71]
    ds_read_b64_tr_b16 v[48:49], v10 offset:30720
    ds_read_b64_tr_b16 v[50:51], v10 offset:31232
    v_mfma_f32_32x32x16_bf16 v[72:87], v[216:219], v[28:31], v[72:87]
    ds_read_b64_tr_b16 v[52:53], v11 offset:30720
    ds_read_b64_tr_b16 v[54:55], v11 offset:31232
CD_C1B24:
    s_waitcnt vmcnt(0)
    v_readfirstlane_b32 s12, v20
    v_readfirstlane_b32 s13, v21
    s_cmp_eq_u32 s12, 0
    s_cbranch_scc1 Lnp_16
Lnd_17:
    s_waitcnt lgkmcnt(8)
    v_mfma_f32_32x32x16_bf16 v[56:71], v[220:223], v[32:35], v[56:71]
    v_add_u32 v10, 90112, v8
    v_add_u32 v11, 90112, v9
    ds_read_b64_tr_b16 v[24:25], v10 offset:0
    v_and_b32 v20, 15, v0
    v_lshrrev_b32 v21, 5, v0
    v_xor_b32 v20, v20, v21
    v_and_b32 v21, 31, v0
    v_lshlrev_b32 v21, 8, v21
    v_lshl_add_u32 v20, v20, 4, v21
    v_mfma_f32_32x32x16_bf16 v[72:87], v[220:223], v[36:39], v[72:87]
    ds_read_b64_tr_b16 v[26:27], v10 offset:512
    ds_read_b64_tr_b16 v[28:29], v11 offset:0
    ds_read_b64_tr_b16 v[30:31], v11 offset:512
    s_lshl_b32 s58, s3, 13
    s_add_u32 s58, s58, 0x10000
    v_add_u32 v20, s58, v20
    v_lshrrev_b32 v21, 3, v0
    s_lshl_b32 s58, s3, 3
    v_add_u32 v21, s58, v21
CD_C1B25:
    s_waitcnt lgkmcnt(8)
    v_mfma_f32_32x32x16_bf16 v[56:71], v[224:227], v[40:43], v[56:71]
    ds_read_b64_tr_b16 v[32:33], v10 offset:2048
    ds_read_b64_tr_b16 v[34:35], v10 offset:2560
    v_and_b32 v22, 7, v0
    v_lshlrev_b32 v22, 1, v22
    v_xor_b32 v22, v22, v21
    v_and_b32 v22, 15, v22
    v_lshlrev_b32 v22, 4, v22
    v_lshl_add_u32 v22, v21, 8, v22
    v_mfma_f32_32x32x16_bf16 v[72:87], v[224:227], v[44:47], v[72:87]
    ds_read_b64_tr_b16 v[36:37], v11 offset:2048
    ds_read_b64_tr_b16 v[38:39], v11 offset:2560
    v_add_u32 v22, 0x10000, v22
    v_xor_b32 v23, 16, v22
CD_C1B26:
    s_waitcnt lgkmcnt(8)
    v_mfma_f32_32x32x16_bf16 v[56:71], v[228:231], v[48:51], v[56:71]
    ds_read_b64_tr_b16 v[40:41], v10 offset:4096
    ds_read_b64_tr_b16 v[42:43], v10 offset:4608
    v_mfma_f32_32x32x16_bf16 v[72:87], v[228:231], v[52:55], v[72:87]
    ds_read_b64_tr_b16 v[44:45], v11 offset:4096
    ds_read_b64_tr_b16 v[46:47], v11 offset:4608
CD_C1B27:
    s_waitcnt lgkmcnt(8)
    v_mfma_f32_32x32x16_bf16 v[56:71], v[232:235], v[24:27], v[56:71]
    ds_read_b64_tr_b16 v[48:49], v10 offset:6144
    ds_read_b64_tr_b16 v[50:51], v10 offset:6656
    v_mfma_f32_32x32x16_bf16 v[72:87], v[232:235], v[28:31], v[72:87]
    ds_read_b64_tr_b16 v[52:53], v11 offset:6144
    ds_read_b64_tr_b16 v[54:55], v11 offset:6656
CD_C1B28:
    s_waitcnt lgkmcnt(8)
    v_mfma_f32_32x32x16_bf16 v[56:71], v[236:239], v[32:35], v[56:71]
    v_mfma_f32_32x32x16_bf16 v[72:87], v[236:239], v[36:39], v[72:87]
CD_C1B29:
    s_waitcnt lgkmcnt(4)
    v_mfma_f32_32x32x16_bf16 v[56:71], v[240:243], v[40:43], v[56:71]
    v_mfma_f32_32x32x16_bf16 v[72:87], v[240:243], v[44:47], v[72:87]
CD_C1B30:
    s_waitcnt lgkmcnt(0)
    v_mfma_f32_32x32x16_bf16 v[56:71], v[244:247], v[48:51], v[56:71]
    v_and_b32 v243, 7, v0
    v_lshlrev_b32 v243, 4, v243
    v_lshl_add_u32 v243, v21, 10, v243
    v_mfma_f32_32x32x16_bf16 v[72:87], v[244:247], v[52:55], v[72:87]
CD_C1B31:
    v_bfe_u32 v247, v0, 2, 1
    v_lshlrev_b32 v247, 7, v247
    v_and_or_b32 v247, v0, 3, v247
    v_lshlrev_b32 v247, 2, v247
    v_add_u32 v247, 131072, v247
    v_lshl_add_u32 v244, v159, 10, v3
    v_mul_u32_u24 v246, 128, v158
    v_mul_u32_u24 v245, 128, v0
    v_mov_b32 v241, v12
    s_mov_b32 s28, s18
    s_mov_b32 s29, s26
    s_mov_b32 s30, s27
    s_add_u32 s31, s11, 131072
    s_mov_b32 s25, 2
    v_lshlrev_b32 v242, 2, v1
    s_nop 4
    v_cvt_pk_bf16_f32 v224, v56, v57
    v_cvt_pk_bf16_f32 v225, v58, v59
    v_cvt_pk_bf16_f32 v226, v60, v61
    v_cvt_pk_bf16_f32 v227, v62, v63
    v_cvt_pk_bf16_f32 v228, v64, v65
    v_cvt_pk_bf16_f32 v229, v66, v67
    v_cvt_pk_bf16_f32 v230, v68, v69
    v_cvt_pk_bf16_f32 v231, v70, v71
    v_cvt_pk_bf16_f32 v232, v72, v73
    v_cvt_pk_bf16_f32 v233, v74, v75
    v_cvt_pk_bf16_f32 v234, v76, v77
    v_cvt_pk_bf16_f32 v235, v78, v79
    v_cvt_pk_bf16_f32 v236, v80, v81
    v_cvt_pk_bf16_f32 v237, v82, v83
    v_cvt_pk_bf16_f32 v238, v84, v85
    v_cvt_pk_bf16_f32 v239, v86, v87
    v_mov_b32 v240, v104
    s_branch L_P2
.p2align 6
PG_J:
    s_setpc_b64 s[100:101]
L_P2:
    s_lshl_b32 s16, s8, 17
    s_add_u32 s16, s16, 0x400000
    s_add_u32 s17, s16, 0x400000
    s_lshl_b32 s18, s3, 10
    s_add_u32 s19, s17, s18
    s_lshl_b32 s22, s9, 14
    s_add_u32 s22, s22, 16384
    s_mul_i32 s21, s5, 16384
    s_add_u32 s21, s21, 0x1080000
CD_Ph:
    s_barrier
    ds_read_b128 v[8:11], v156
    ds_read_b128 v[24:27], v153 offset:0
    ds_read_b128 v[28:31], v153 offset:2048
    s_mov_b64 exec, s[56:57]
    ds_read_b128 v[120:123], v153 offset:1024
    s_mov_b64 exec, 0x3f8
    s_add_u32 s58, s21, 393216
    buffer_load_dwordx2 v[12:13], v246, s[32:35], s58 offen sc1
    s_mov_b64 exec, -1
    s_waitcnt lgkmcnt(2)
    v_mfma_f32_32x32x16_bf16 v[64:79], v[24:27], v[8:11], 0
    ds_read_b128 v[24:27], v153 offset:4096
    s_mov_b64 exec, s[56:57]
    ds_read_b128 v[128:131], v153 offset:1280
    ds_read_b128 v[124:127], v153 offset:3072
    s_mov_b64 exec, -1
    s_waitcnt lgkmcnt(3)
    s_and_b32 s58, s12, 0x3fff3ff0
    v_mov_b32 v110, s58
    v_readlane_b32 s59, v247, s3
    s_setprio 1
    v_mov_b64 v[116:117], -1
    v_mov_b32 v109, s59
    v_max3_f32 v104, v64, v65, v66
    v_max3_f32 v105, v67, v68, v69
    v_max3_f32 v104, v104, v70, v71
    v_max3_f32 v105, v105, v72, v73
    v_max3_f32 v104, v104, v74, v75
    v_max3_f32 v105, v105, v76, v77
    v_max3_f32 v104, v104, v78, v79
    v_max_f32 v104, v104, v105
    v_mov_b32 v105, v104
    s_nop 1
    v_permlane32_swap_b32 v104, v105
    s_nop 1
    v_min_f32 v48, -v104, -v105
    v_min_f32 v49, -v104, -v105
    v_pk_add_f32 v[64:65], v[64:65], v[48:49]
    v_pk_add_f32 v[66:67], v[66:67], v[48:49]
    v_mov_b64 v[50:51], v[48:49]
    v_pk_add_f32 v[68:69], v[68:69], v[48:49]
    v_mov_b64 v[52:53], v[48:49]
    v_pk_add_f32 v[70:71], v[70:71], v[48:49]
    v_mov_b64 v[54:55], v[48:49]
    v_pk_add_f32 v[72:73], v[72:73], v[48:49]
    v_mov_b64 v[56:57], v[48:49]
    v_pk_add_f32 v[74:75], v[74:75], v[48:49]
    v_mov_b64 v[58:59], v[48:49]
    v_pk_add_f32 v[76:77], v[76:77], v[48:49]
    v_mov_b64 v[60:61], v[48:49]
    v_pk_add_f32 v[78:79], v[78:79], v[48:49]
    v_mov_b64 v[62:63], v[48:49]
    s_setprio 0
    v_exp_f32 v64, v64
    s_setprio 1
    v_exp_f32 v65, v65
    v_exp_f32 v66, v66
    v_exp_f32 v67, v67
    v_exp_f32 v68, v68
    v_exp_f32 v69, v69
    v_exp_f32 v70, v70
    v_exp_f32 v71, v71
    v_mfma_f32_32x32x16_bf16 v[88:103], v[28:31], v[8:11], v[48:63]
    v_exp_f32 v72, v72
    v_exp_f32 v73, v73
    v_exp_f32 v74, v74
    v_exp_f32 v75, v75
    v_smfmac_f32_32x32x32_bf16 v[176:191], v[120:123], v[64:71], v152
    v_exp_f32 v76, v76
    v_exp_f32 v77, v77
    v_exp_f32 v78, v78
    s_setprio 0
    v_exp_f32 v79, v79
    ds_read_b128 v[28:31], v153 offset:6144
    s_mov_b64 exec, s[56:57]
    ds_read_b128 v[132:135], v153 offset:3328
    ds_read_b128 v[120:123], v153 offset:5120
    s_mov_b64 exec, -1
    s_lshl_b32 s58, s10, 6
    s_add_u32 s58, s58, s8
    s_lshl_b32 s14, s58, 10
    s_add_u32 s14, s14, 0xc00000
    s_add_u32 s15, s14, 0x8000
    s_lshl_b32 s11, s10, 5
    s_add_u32 s11, s11, s8
    s_mul_i32 s11, s11, 128
    s_add_u32 s11, s11, 0x1100000
CD_P0:
    s_branch SK_P0
.p2align 12
PG_P0:
    s_setpc_b64 s[100:101]
SK_P0:
    s_waitcnt lgkmcnt(3)
    v_exp_f32 v88, v88
    s_setprio 1
    v_exp_f32 v89, v89
    v_exp_f32 v90, v90
    v_exp_f32 v91, v91
    v_smfmac_f32_32x32x32_bf16 v[176:191], v[128:131], v[72:79], v152
    v_exp_f32 v92, v92
    v_exp_f32 v93, v93
    v_exp_f32 v94, v94
    v_exp_f32 v95, v95
    v_mfma_f32_32x32x16_bf16 v[64:79], v[24:27], v[8:11], v[48:63]
    v_exp_f32 v96, v96
    v_exp_f32 v97, v97
    v_exp_f32 v98, v98
    v_exp_f32 v99, v99
    v_smfmac_f32_32x32x32_bf16 v[176:191], v[124:127], v[88:95], v152
    v_exp_f32 v100, v100
    v_exp_f32 v101, v101
    v_exp_f32 v102, v102
    s_setprio 0
    v_exp_f32 v103, v103
    ds_read_b128 v[24:27], v153 offset:8192
    s_mov_b64 exec, s[56:57]
    ds_read_b128 v[128:131], v153 offset:5376
    ds_read_b128 v[124:127], v153 offset:7168
    s_mov_b64 exec, -1
    s_lshr_b32 s48, s8, 3
    s_lshl_b32 s49, s9, 2
    s_add_u32 s48, s48, s49
    s_lshl_b32 s48, s48, 1
    s_and_b32 s49, s3, 1
    s_add_u32 s48, s48, s49
    s_lshr_b32 s49, s3, 1
    s_and_b32 s50, s8, 7
    s_lshl_b32 s51, s48, 5
    s_lshl_b32 s58, s49, 3
    s_add_u32 s51, s51, s58
    s_mul_i32 s53, s51, 128
    s_add_u32 s53, s53, 0x1100000
    s_waitcnt vmcnt(0)
CD_P1:
    s_waitcnt lgkmcnt(3)
    v_exp_f32 v64, v64
    s_setprio 1
    v_exp_f32 v65, v65
    v_exp_f32 v66, v66
    v_exp_f32 v67, v67
    v_smfmac_f32_32x32x32_bf16 v[176:191], v[132:135], v[96:103], v152
    v_exp_f32 v68, v68
    v_exp_f32 v69, v69
    v_exp_f32 v70, v70
    v_exp_f32 v71, v71
    v_mfma_f32_32x32x16_bf16 v[88:103], v[28:31], v[8:11], v[48:63]
    v_exp_f32 v72, v72
    v_exp_f32 v73, v73
    v_exp_f32 v74, v74
    v_exp_f32 v75, v75
    v_smfmac_f32_32x32x32_bf16 v[176:191], v[120:123], v[64:71], v152
    v_exp_f32 v76, v76
    v_exp_f32 v77, v77
    v_exp_f32 v78, v78
    v_cmp_ne_u64 vcc, s[12:13], v[12:13]
    s_setprio 0
    v_exp_f32 v79, v79
    s_and_b32 s58, vcc_lo, 0x3f8
    s_cbranch_scc1 LF1_18
LF1d_19:
    ds_read_b128 v[28:31], v153 offset:10240
    s_mov_b64 exec, s[56:57]
    ds_read_b128 v[132:135], v153 offset:7424
    ds_read_b128 v[120:123], v153 offset:9216
    s_mov_b64 exec, -1
    s_add_u32 s22, s22, 8192
    s_and_b32 s22, s22, 0x1ffff
    s_add_u32 m0, s18, 24576
    s_add_u32 s58, s22, s19
    buffer_load_dwordx4 v2, s[32:35], s58 offen sc1 lds
    s_add_u32 s22, s22, 8192
    s_and_b32 s22, s22, 0x1ffff
    s_add_u32 m0, s18, 32768
    s_add_u32 s58, s22, s19
    buffer_load_dwordx4 v2, s[32:35], s58 offen sc1 lds
CD_P2:
    s_waitcnt lgkmcnt(3)
    v_exp_f32 v88, v88
    s_setprio 1
    v_exp_f32 v89, v89
    v_exp_f32 v90, v90
    v_exp_f32 v91, v91
    v_smfmac_f32_32x32x32_bf16 v[176:191], v[128:131], v[72:79], v152
    v_exp_f32 v92, v92
    v_exp_f32 v93, v93
    v_exp_f32 v94, v94
    v_exp_f32 v95, v95
    v_mfma_f32_32x32x16_bf16 v[64:79], v[24:27], v[8:11], v[48:63]
    v_exp_f32 v96, v96
    v_exp_f32 v97, v97
    v_exp_f32 v98, v98
    v_exp_f32 v99, v99
    v_smfmac_f32_32x32x32_bf16 v[176:191], v[124:127], v[88:95], v152
    v_exp_f32 v100, v100
    v_exp_f32 v101, v101
    v_exp_f32 v102, v102
    s_setprio 0
    v_exp_f32 v103, v103
    ds_read_b128 v[24:27], v153 offset:12288
    s_mov_b64 exec, s[56:57]
    ds_read_b128 v[128:131], v153 offset:9472
    ds_read_b128 v[124:127], v153 offset:11264
    s_mov_b64 exec, -1
    s_add_u32 s22, s22, 8192
    s_and_b32 s22, s22, 0x1ffff
    s_add_u32 m0, s18, 40960
    s_add_u32 s58, s22, s19
    buffer_load_dwordx4 v2, s[32:35], s58 offen sc1 lds
CD_P3:
    s_waitcnt lgkmcnt(3)
    v_exp_f32 v64, v64
    s_setprio 1
    v_exp_f32 v65, v65
    v_exp_f32 v66, v66
    v_exp_f32 v67, v67
    v_smfmac_f32_32x32x32_bf16 v[176:191], v[132:135], v[96:103], v152
    v_exp_f32 v68, v68
    v_exp_f32 v69, v69
    v_exp_f32 v70, v70
    v_exp_f32 v71, v71
    v_mfma_f32_32x32x16_bf16 v[88:103], v[28:31], v[8:11], v[48:63]
    v_exp_f32 v72, v72
    v_exp_f32 v73, v73
    v_exp_f32 v74, v74
    v_exp_f32 v75, v75
    v_smfmac_f32_32x32x32_bf16 v[176:191], v[120:123], v[64:71], v152
    v_exp_f32 v76, v76
    v_exp_f32 v77, v77
    v_exp_f32 v78, v78
    s_setprio 0
    v_exp_f32 v79, v79
    ds_read_b128 v[28:31], v153 offset:14336
    s_mov_b64 exec, s[56:57]
    ds_read_b128 v[132:135], v153 offset:11520
    ds_read_b128 v[120:123], v153 offset:13312
    s_mov_b64 exec, -1
    s_add_u32 s22, s22, 8192
    s_and_b32 s22, s22, 0x1ffff
    s_add_u32 m0, s18, 49152
    s_add_u32 s58, s22, s19
    buffer_load_dwordx4 v2, s[32:35], s58 offen sc1 lds
CD_P4:
    s_waitcnt lgkmcnt(3)
    v_exp_f32 v88, v88
    s_setprio 1
    v_exp_f32 v89, v89
    v_exp_f32 v90, v90
    v_exp_f32 v91, v91
    v_smfmac_f32_32x32x32_bf16 v[176:191], v[128:131], v[72:79], v152
    v_exp_f32 v92, v92
    v_exp_f32 v93, v93
    v_exp_f32 v94, v94
    v_exp_f32 v95, v95
    v_mfma_f32_32x32x16_bf16 v[64:79], v[24:27], v[8:11], v[48:63]
    v_exp_f32 v96, v96
    v_exp_f32 v97, v97
    v_exp_f32 v98, v98
    v_exp_f32 v99, v99
    v_smfmac_f32_32x32x32_bf16 v[176:191], v[124:127], v[88:95], v152
    v_exp_f32 v100, v100
    v_exp_f32 v101, v101
    v_exp_f32 v102, v102
    s_setprio 0
    v_exp_f32 v103, v103
    ds_read_b128 v[24:27], v153 offset:16384
    s_mov_b64 exec, s[56:57]
    ds_read_b128 v[128:131], v153 offset:13568
    ds_read_b128 v[124:127], v153 offset:15360
    s_mov_b64 exec, -1
    s_add_u32 s22, s22, 8192
    s_and_b32 s22, s22, 0x1ffff
    s_add_u32 m0, s18, 57344
    s_add_u32 s58, s22, s19
    buffer_load_dwordx4 v2, s[32:35], s58 offen sc1 lds
    s_mov_b64 exec, 0xfc00
    buffer_load_dwordx2 v[12:13], v246, s[32:35], s21 offen sc1
    s_mov_b64 exec, -1
CD_P5:
    s_waitcnt lgkmcnt(3)
    v_exp_f32 v64, v64
    s_setprio 1
    v_exp_f32 v65, v65
    v_exp_f32 v66, v66
    v_exp_f32 v67, v67
    v_smfmac_f32_32x32x32_bf16 v[176:191], v[132:135], v[96:103], v152
    v_exp_f32 v68, v68
    v_exp_f32 v69, v69
    v_exp_f32 v70, v70
    v_exp_f32 v71, v71
    v_mfma_f32_32x32x16_bf16 v[88:103], v[28:31], v[8:11], v[48:63]
    v_exp_f32 v72, v72
    v_exp_f32 v73, v73
    v_exp_f32 v74, v74
    v_exp_f32 v75, v75
    v_smfmac_f32_32x32x32_bf16 v[176:191], v[120:123], v[64:71], v152
    v_exp_f32 v76, v76
    v_exp_f32 v77, v77
    v_exp_f32 v78, v78
    v_add_u32 v3, 1, v110
    s_setprio 0
    v_exp_f32 v79, v79
    s_waitcnt vmcnt(3)
    ds_read_b128 v[28:31], v153 offset:18432
    ds_write_b32 v109, v3
    s_mov_b64 exec, s[56:57]
    ds_read_b128 v[132:135], v153 offset:15616
    ds_read_b128 v[120:123], v153 offset:17408
    s_mov_b64 exec, -1
    s_add_u32 s22, s22, 8192
    s_and_b32 s22, s22, 0x1ffff
    s_add_u32 m0, s18, 65536
    s_add_u32 s58, s22, s19
    buffer_load_dwordx4 v2, s[32:35], s58 offen sc1 lds
CD_P6:
    s_waitcnt lgkmcnt(4)
    v_exp_f32 v88, v88
    s_setprio 1
    v_exp_f32 v89, v89
    v_exp_f32 v90, v90
    v_exp_f32 v91, v91
    v_smfmac_f32_32x32x32_bf16 v[176:191], v[128:131], v[72:79], v152
    v_exp_f32 v92, v92
    v_exp_f32 v93, v93
    v_exp_f32 v94, v94
    v_exp_f32 v95, v95
    v_mfma_f32_32x32x16_bf16 v[64:79], v[24:27], v[8:11], v[48:63]
    v_exp_f32 v96, v96
    v_exp_f32 v97, v97
    v_exp_f32 v98, v98
    v_exp_f32 v99, v99
    v_smfmac_f32_32x32x32_bf16 v[176:191], v[124:127], v[88:95], v152
    v_exp_f32 v100, v100
    v_exp_f32 v101, v101
    v_exp_f32 v102, v102
    v_mov_b64 v[118:119], -1
    v_mov_b64 v[112:113], s[12:13]
    v_mov_b32 v114, 0
    v_and_b32 v115, 31, v0
    v_lshlrev_b32 v115, 2, v115
    s_setprio 0
    v_exp_f32 v103, v103
    ds_read_b128 v[24:27], v153 offset:20480
    ds_read_b32 v108, v247
    s_mov_b64 exec, s[56:57]
    ds_read_b128 v[128:131], v153 offset:17664
    ds_read_b128 v[124:127], v153 offset:19456
    s_mov_b64 exec, -1
    s_add_u32 s22, s22, 8192
    s_and_b32 s22, s22, 0x1ffff
    s_add_u32 m0, s18, 73728
    s_add_u32 s58, s22, s19
    buffer_load_dwordx4 v2, s[32:35], s58 offen sc1 lds
    s_waitcnt vmcnt(2)
CD_P7:
    s_waitcnt lgkmcnt(4)
    v_exp_f32 v64, v64
    s_setprio 1
    v_exp_f32 v65, v65
    v_exp_f32 v66, v66
    v_exp_f32 v67, v67
    v_smfmac_f32_32x32x32_bf16 v[176:191], v[132:135], v[96:103], v152
    v_exp_f32 v68, v68
    v_exp_f32 v69, v69
    v_exp_f32 v70, v70
    v_exp_f32 v71, v71
    v_mfma_f32_32x32x16_bf16 v[88:103], v[28:31], v[8:11], v[48:63]
    v_exp_f32 v72, v72
    v_exp_f32 v73, v73
    v_exp_f32 v74, v74
    v_exp_f32 v75, v75
    v_smfmac_f32_32x32x32_bf16 v[176:191], v[120:123], v[64:71], v152
    v_exp_f32 v76, v76
    v_exp_f32 v77, v77
    v_exp_f32 v78, v78
    v_cmp_ne_u64 vcc, s[12:13], v[12:13]
    s_setprio 0
    v_exp_f32 v79, v79
    s_and_b32 s58, vcc_lo, 0xfc00
    s_cbranch_scc1 LF2_23
LF2d_24:
    ds_read_b128 v[28:31], v153 offset:22528
    s_mov_b64 exec, s[56:57]
    ds_read_b128 v[132:135], v153 offset:19712
    ds_read_b128 v[120:123], v153 offset:21504
    s_mov_b64 exec, -1
    s_lshl_b32 s54, s48, 16
    s_lshl_b32 s58, s49, 13
    s_add_u32 s54, s54, s58
    s_add_u32 s54, s54, 0xc00000
    s_add_u32 s51, s54, 0x8000
    s_add_u32 s52, s54, 0x9000
    s_add_u32 s55, s54, 0x1000
    s_lshl_b32 s23, s50, 7
    s_lshl_b32 s58, s3, 13
    s_add_u32 s23, s23, s58
CD_P8:
    s_waitcnt lgkmcnt(3)
    v_exp_f32 v88, v88
    s_setprio 1
    v_exp_f32 v89, v89
    v_exp_f32 v90, v90
    v_exp_f32 v91, v91
    v_smfmac_f32_32x32x32_bf16 v[176:191], v[128:131], v[72:79], v152
    v_exp_f32 v92, v92
    v_exp_f32 v93, v93
    v_exp_f32 v94, v94
    v_exp_f32 v95, v95
    v_mfma_f32_32x32x16_bf16 v[64:79], v[24:27], v[8:11], v[48:63]
    v_exp_f32 v96, v96
    v_exp_f32 v97, v97
    v_exp_f32 v98, v98
    v_exp_f32 v99, v99
    v_smfmac_f32_32x32x32_bf16 v[176:191], v[124:127], v[88:95], v152
    v_exp_f32 v100, v100
    v_sub_u32 v108, v108, v3
    v_exp_f32 v101, v101
    v_exp_f32 v102, v102
    v_cmp_lt_u32 vcc, 3, v108
    s_setprio 0
    v_exp_f32 v103, v103
    s_cbranch_vccnz Lsy_21
Lsyd_22:
    ds_read_b128 v[24:27], v153 offset:24576
    s_mov_b64 exec, s[56:57]
    ds_read_b128 v[128:131], v153 offset:21760
    ds_read_b128 v[124:127], v153 offset:23552
    s_mov_b64 exec, -1
    s_add_u32 s22, s22, 8192
    s_and_b32 s22, s22, 0x1ffff
    s_add_u32 m0, s18, 81920
    s_add_u32 s58, s22, s19
    buffer_load_dwordx4 v2, s[32:35], s58 offen sc1 lds
CD_P9:
    s_waitcnt lgkmcnt(3)
    v_exp_f32 v64, v64
    s_setprio 1
    v_exp_f32 v65, v65
    v_exp_f32 v66, v66
    v_exp_f32 v67, v67
    v_smfmac_f32_32x32x32_bf16 v[176:191], v[132:135], v[96:103], v152
    v_exp_f32 v68, v68
    v_exp_f32 v69, v69
    v_exp_f32 v70, v70
    v_exp_f32 v71, v71
    v_mfma_f32_32x32x16_bf16 v[88:103], v[28:31], v[8:11], v[48:63]
    v_exp_f32 v72, v72
    v_exp_f32 v73, v73
    v_exp_f32 v74, v74
    v_exp_f32 v75, v75
    v_smfmac_f32_32x32x32_bf16 v[176:191], v[120:123], v[64:71], v152
    v_exp_f32 v76, v76
    v_exp_f32 v77, v77
    v_exp_f32 v78, v78
    s_setprio 0
    v_exp_f32 v79, v79
    ds_read_b128 v[28:31], v153 offset:26624
    s_mov_b64 exec, s[56:57]
    ds_read_b128 v[132:135], v153 offset:23808
    ds_read_b128 v[120:123], v153 offset:25600
    s_mov_b64 exec, -1
    s_add_u32 s22, s22, 8192
    s_and_b32 s22, s22, 0x1ffff
    s_add_u32 m0, s18, 90112
    s_add_u32 s58, s22, s19
    buffer_load_dwordx4 v2, s[32:35], s58 offen sc1 lds
CD_P10:
    s_waitcnt lgkmcnt(3)
    v_exp_f32 v88, v88
    s_setprio 1
    v_exp_f32 v89, v89
    v_exp_f32 v90, v90
    v_exp_f32 v91, v91
    v_smfmac_f32_32x32x32_bf16 v[176:191], v[128:131], v[72:79], v152
    v_exp_f32 v92, v92
    v_exp_f32 v93, v93
    v_exp_f32 v94, v94
    v_exp_f32 v95, v95
    v_mfma_f32_32x32x16_bf16 v[64:79], v[24:27], v[8:11], v[48:63]
    v_exp_f32 v96, v96
    v_exp_f32 v97, v97
    v_exp_f32 v98, v98
    v_exp_f32 v99, v99
    v_smfmac_f32_32x32x32_bf16 v[176:191], v[124:127], v[88:95], v152
    v_exp_f32 v100, v100
    v_exp_f32 v101, v101
    v_exp_f32 v102, v102
    s_setprio 0
    v_exp_f32 v103, v103
    ds_read_b128 v[24:27], v153 offset:28672
    s_mov_b64 exec, s[56:57]
    ds_read_b128 v[128:131], v153 offset:25856
    ds_read_b128 v[124:127], v153 offset:27648
    s_mov_b64 exec, -1
    s_add_u32 s22, s22, 8192
    s_and_b32 s22, s22, 0x1ffff
    s_add_u32 m0, s18, 98304
    s_add_u32 s58, s22, s19
    buffer_load_dwordx4 v2, s[32:35], s58 offen sc1 lds
CD_P11:
    s_waitcnt lgkmcnt(3)
    v_exp_f32 v64, v64
    s_setprio 1
    v_exp_f32 v65, v65
    v_exp_f32 v66, v66
    v_exp_f32 v67, v67
    v_smfmac_f32_32x32x32_bf16 v[176:191], v[132:135], v[96:103], v152
    v_exp_f32 v68, v68
    v_exp_f32 v69, v69
    v_exp_f32 v70, v70
    v_exp_f32 v71, v71
    v_mfma_f32_32x32x16_bf16 v[88:103], v[28:31], v[8:11], v[48:63]
    v_exp_f32 v72, v72
    v_exp_f32 v73, v73
    v_exp_f32 v74, v74
    v_exp_f32 v75, v75
    v_smfmac_f32_32x32x32_bf16 v[176:191], v[120:123], v[64:71], v152
    v_exp_f32 v76, v76
    v_exp_f32 v77, v77
    v_exp_f32 v78, v78
    s_setprio 0
    v_exp_f32 v79, v79
    ds_read_b128 v[28:31], v153 offset:30720
    s_mov_b64 exec, s[56:57]
    ds_read_b128 v[132:135], v153 offset:27904
    ds_read_b128 v[120:123], v153 offset:29696
    s_mov_b64 exec, -1
    s_add_u32 s22, s22, 8192
    s_and_b32 s22, s22, 0x1ffff
    s_add_u32 m0, s18, 106496
    s_add_u32 s58, s22, s19
    buffer_load_dwordx4 v2, s[32:35], s58 offen sc1 lds
CD_P12:
    s_waitcnt lgkmcnt(3)
    v_exp_f32 v88, v88
    s_setprio 1
    v_exp_f32 v89, v89
    v_exp_f32 v90, v90
    v_exp_f32 v91, v91
    v_smfmac_f32_32x32x32_bf16 v[176:191], v[128:131], v[72:79], v152
    v_exp_f32 v92, v92
    v_exp_f32 v93, v93
    v_exp_f32 v94, v94
    v_exp_f32 v95, v95
    v_mfma_f32_32x32x16_bf16 v[64:79], v[24:27], v[8:11], v[48:63]
    v_exp_f32 v96, v96
    v_exp_f32 v97, v97
    v_exp_f32 v98, v98
    v_exp_f32 v99, v99
    v_smfmac_f32_32x32x32_bf16 v[176:191], v[124:127], v[88:95], v152
    v_exp_f32 v100, v100
    v_exp_f32 v101, v101
    v_exp_f32 v102, v102
    s_setprio 0
    v_exp_f32 v103, v103
    ds_read_b128 v[24:27], v153 offset:32768
    s_mov_b64 exec, s[56:57]
    ds_read_b128 v[128:131], v153 offset:29952
    ds_read_b128 v[124:127], v153 offset:31744
    s_mov_b64 exec, -1
    s_add_u32 s22, s22, 8192
    s_and_b32 s22, s22, 0x1ffff
    s_add_u32 m0, s18, 114688
    s_add_u32 s58, s22, s19
    buffer_load_dwordx4 v2, s[32:35], s58 offen sc1 lds
CD_P13:
    s_waitcnt lgkmcnt(3)
    v_exp_f32 v64, v64
    s_setprio 1
    v_exp_f32 v65, v65
    v_exp_f32 v66, v66
    v_exp_f32 v67, v67
    v_smfmac_f32_32x32x32_bf16 v[176:191], v[132:135], v[96:103], v152
    v_exp_f32 v68, v68
    v_exp_f32 v69, v69
    v_exp_f32 v70, v70
    v_exp_f32 v71, v71
    v_mfma_f32_32x32x16_bf16 v[88:103], v[28:31], v[8:11], v[48:63]
    v_exp_f32 v72, v72
    v_exp_f32 v73, v73
    v_exp_f32 v74, v74
    v_exp_f32 v75, v75
    v_smfmac_f32_32x32x32_bf16 v[176:191], v[120:123], v[64:71], v152
    v_exp_f32 v76, v76
    v_exp_f32 v77, v77
    v_exp_f32 v78, v78
    s_setprio 0
    v_exp_f32 v79, v79
    ds_read_b128 v[28:31], v153 offset:34816
    s_mov_b64 exec, s[56:57]
    ds_read_b128 v[132:135], v153 offset:32000
    ds_read_b128 v[120:123], v153 offset:33792
    s_mov_b64 exec, -1
    s_add_u32 s22, s22, 8192
    s_and_b32 s22, s22, 0x1ffff
    s_add_u32 m0, s18, 122880
    s_add_u32 s58, s22, s19
    buffer_load_dwordx4 v2, s[32:35], s58 offen sc1 lds
CD_P14:
    s_waitcnt lgkmcnt(3)
    v_exp_f32 v88, v88
    s_setprio 1
    v_exp_f32 v89, v89
    v_exp_f32 v90, v90
    v_exp_f32 v91, v91
    v_smfmac_f32_32x32x32_bf16 v[176:191], v[128:131], v[72:79], v152
    v_exp_f32 v92, v92
    v_exp_f32 v93, v93
    v_exp_f32 v94, v94
    v_exp_f32 v95, v95
    v_mfma_f32_32x32x16_bf16 v[64:79], v[24:27], v[8:11], v[48:63]
    v_exp_f32 v96, v96
    v_exp_f32 v97, v97
    v_exp_f32 v98, v98
    v_exp_f32 v99, v99
    v_smfmac_f32_32x32x32_bf16 v[176:191], v[124:127], v[88:95], v152
    v_exp_f32 v100, v100
    v_exp_f32 v101, v101
    v_exp_f32 v102, v102
    s_setprio 0
    v_exp_f32 v103, v103
    ds_read_b128 v[24:27], v153 offset:36864
    s_mov_b64 exec, s[56:57]
    ds_read_b128 v[128:131], v153 offset:34048
    ds_read_b128 v[124:127], v153 offset:35840
    s_mov_b64 exec, -1
CD_P15:
    s_waitcnt lgkmcnt(3)
    v_exp_f32 v64, v64
    s_setprio 1
    v_exp_f32 v65, v65
    v_exp_f32 v66, v66
    v_exp_f32 v67, v67
    v_smfmac_f32_32x32x32_bf16 v[176:191], v[132:135], v[96:103], v152
    v_exp_f32 v68, v68
    v_exp_f32 v69, v69
    v_exp_f32 v70, v70
    v_exp_f32 v71, v71
    v_mfma_f32_32x32x16_bf16 v[88:103], v[28:31], v[8:11], v[48:63]
    v_exp_f32 v72, v72
    v_exp_f32 v73, v73
    v_exp_f32 v74, v74
    v_exp_f32 v75, v75
    v_smfmac_f32_32x32x32_bf16 v[176:191], v[120:123], v[64:71], v152
    v_exp_f32 v76, v76
    v_exp_f32 v77, v77
    v_exp_f32 v78, v78
    s_setprio 0
    v_exp_f32 v79, v79
    ds_read_b128 v[28:31], v153 offset:38912
    s_mov_b64 exec, s[56:57]
    ds_read_b128 v[132:135], v153 offset:36096
    ds_read_b128 v[120:123], v153 offset:37888
    s_mov_b64 exec, -1
    s_lshl_b32 s20, s9, 3
    s_lshl_b32 s58, s3, 1
    s_add_u32 s20, s20, s58
    s_sub_i32 s20, s20, 8
    s_max_i32 s20, s20, 0
    s_lshl_b32 s20, s20, 11
    s_add_u32 s20, s20, s16
CD_P16:
    s_waitcnt lgkmcnt(3)
    v_exp_f32 v88, v88
    s_setprio 1
    v_exp_f32 v89, v89
    v_exp_f32 v90, v90
    v_exp_f32 v91, v91
    v_smfmac_f32_32x32x32_bf16 v[176:191], v[128:131], v[72:79], v152
    v_exp_f32 v92, v92
    v_exp_f32 v93, v93
    v_exp_f32 v94, v94
    v_exp_f32 v95, v95
    v_mfma_f32_32x32x16_bf16 v[64:79], v[24:27], v[8:11], v[48:63]
    v_exp_f32 v96, v96
    v_exp_f32 v97, v97
    v_exp_f32 v98, v98
    v_exp_f32 v99, v99
    v_smfmac_f32_32x32x32_bf16 v[176:191], v[124:127], v[88:95], v152
    v_exp_f32 v100, v100
    v_exp_f32 v101, v101
    v_exp_f32 v102, v102
    s_setprio 0
    v_exp_f32 v103, v103
    ds_read_b128 v[24:27], v153 offset:40960
    s_mov_b64 exec, s[56:57]
    ds_read_b128 v[128:131], v153 offset:38144
    ds_read_b128 v[124:127], v153 offset:39936
    s_mov_b64 exec, -1
    s_lshr_b32 s63, s48, 1
    s_lshl_b32 s63, s63, 16
    s_lshl_b32 s59, s50, 7
    s_add_u32 s63, s63, s59
CD_P17:
    s_waitcnt lgkmcnt(3)
    v_exp_f32 v64, v64
    s_setprio 1
    v_exp_f32 v65, v65
    v_exp_f32 v66, v66
    v_exp_f32 v67, v67
    v_smfmac_f32_32x32x32_bf16 v[176:191], v[132:135], v[96:103], v152
    v_exp_f32 v68, v68
    v_exp_f32 v69, v69
    v_exp_f32 v70, v70
    v_exp_f32 v71, v71
    v_mfma_f32_32x32x16_bf16 v[88:103], v[28:31], v[8:11], v[48:63]
    v_exp_f32 v72, v72
    v_exp_f32 v73, v73
    v_exp_f32 v74, v74
    v_exp_f32 v75, v75
    v_smfmac_f32_32x32x32_bf16 v[176:191], v[120:123], v[64:71], v152
    v_exp_f32 v76, v76
    v_exp_f32 v77, v77
    v_exp_f32 v78, v78
    v_add_u32 v3, 2, v110
    s_setprio 0
    v_exp_f32 v79, v79
    s_waitcnt vmcnt(0)
    ds_read_b128 v[28:31], v153 offset:43008
    ds_write_b32 v109, v3
    s_mov_b64 exec, s[56:57]
    ds_read_b128 v[132:135], v153 offset:40192
    ds_read_b128 v[120:123], v153 offset:41984
    s_mov_b64 exec, -1
CD_P18:
    s_waitcnt lgkmcnt(4)
    v_exp_f32 v88, v88
    s_setprio 1
    v_exp_f32 v89, v89
    v_exp_f32 v90, v90
    v_exp_f32 v91, v91
    v_smfmac_f32_32x32x32_bf16 v[176:191], v[128:131], v[72:79], v152
    v_exp_f32 v92, v92
    v_exp_f32 v93, v93
    v_exp_f32 v94, v94
    v_exp_f32 v95, v95
    v_mfma_f32_32x32x16_bf16 v[64:79], v[24:27], v[8:11], v[48:63]
    v_exp_f32 v96, v96
    v_exp_f32 v97, v97
    v_exp_f32 v98, v98
    v_exp_f32 v99, v99
    v_smfmac_f32_32x32x32_bf16 v[176:191], v[124:127], v[88:95], v152
    v_exp_f32 v100, v100
    v_exp_f32 v101, v101
    v_exp_f32 v102, v102
    s_setprio 0
    v_exp_f32 v103, v103
    ds_read_b128 v[24:27], v153 offset:45056
    ds_read_b32 v108, v247
    s_mov_b64 exec, s[56:57]
    ds_read_b128 v[128:131], v153 offset:42240
    ds_read_b128 v[124:127], v153 offset:44032
    s_mov_b64 exec, -1
CD_P19:
    s_waitcnt lgkmcnt(4)
    v_exp_f32 v64, v64
    s_setprio 1
    v_exp_f32 v65, v65
    v_exp_f32 v66, v66
    v_exp_f32 v67, v67
    v_smfmac_f32_32x32x32_bf16 v[176:191], v[132:135], v[96:103], v152
    v_exp_f32 v68, v68
    v_exp_f32 v69, v69
    v_exp_f32 v70, v70
    v_exp_f32 v71, v71
    v_mfma_f32_32x32x16_bf16 v[88:103], v[28:31], v[8:11], v[48:63]
    v_exp_f32 v72, v72
    v_exp_f32 v73, v73
    v_exp_f32 v74, v74
    v_exp_f32 v75, v75
    v_smfmac_f32_32x32x32_bf16 v[176:191], v[120:123], v[64:71], v152
    v_exp_f32 v76, v76
    v_exp_f32 v77, v77
    v_exp_f32 v78, v78
    s_setprio 0
    v_exp_f32 v79, v79
    ds_read_b128 v[28:31], v153 offset:47104
    s_mov_b64 exec, s[56:57]
    ds_read_b128 v[132:135], v153 offset:44288
    ds_read_b128 v[120:123], v153 offset:46080
    s_mov_b64 exec, -1
CD_P20:
    s_waitcnt lgkmcnt(3)
    v_exp_f32 v88, v88
    s_setprio 1
    v_exp_f32 v89, v89
    v_exp_f32 v90, v90
    v_exp_f32 v91, v91
    v_smfmac_f32_32x32x32_bf16 v[176:191], v[128:131], v[72:79], v152
    v_exp_f32 v92, v92
    v_exp_f32 v93, v93
    v_exp_f32 v94, v94
    v_exp_f32 v95, v95
    v_mfma_f32_32x32x16_bf16 v[64:79], v[24:27], v[8:11], v[48:63]
    v_exp_f32 v96, v96
    v_exp_f32 v97, v97
    v_exp_f32 v98, v98
    v_exp_f32 v99, v99
    v_smfmac_f32_32x32x32_bf16 v[176:191], v[124:127], v[88:95], v152
    v_exp_f32 v100, v100
    v_sub_u32 v108, v3, v108
    v_exp_f32 v101, v101
    v_exp_f32 v102, v102
    v_cmp_eq_u32 vcc, 1, v108
    s_setprio 0
    v_exp_f32 v103, v103
    s_cbranch_vccnz Lsy_31
Lsyd_32:
    ds_read_b128 v[24:27], v153 offset:49152
    s_mov_b64 exec, s[56:57]
    ds_read_b128 v[128:131], v153 offset:46336
    ds_read_b128 v[124:127], v153 offset:48128
    s_mov_b64 exec, -1
CD_P21:
    s_waitcnt lgkmcnt(3)
    v_exp_f32 v64, v64
    s_setprio 1
    v_exp_f32 v65, v65
    v_exp_f32 v66, v66
    v_exp_f32 v67, v67
    v_smfmac_f32_32x32x32_bf16 v[176:191], v[132:135], v[96:103], v152
    v_exp_f32 v68, v68
    v_exp_f32 v69, v69
    v_exp_f32 v70, v70
    v_exp_f32 v71, v71
    v_mfma_f32_32x32x16_bf16 v[88:103], v[28:31], v[8:11], v[48:63]
    v_exp_f32 v72, v72
    v_exp_f32 v73, v73
    v_exp_f32 v74, v74
    v_exp_f32 v75, v75
    v_smfmac_f32_32x32x32_bf16 v[176:191], v[120:123], v[64:71], v152
    v_exp_f32 v76, v76
    v_exp_f32 v77, v77
    v_exp_f32 v78, v78
    s_setprio 0
    v_exp_f32 v79, v79
    ds_read_b128 v[28:31], v153 offset:51200
    s_mov_b64 exec, s[56:57]
    ds_read_b128 v[132:135], v153 offset:48384
    ds_read_b128 v[120:123], v153 offset:50176
    s_mov_b64 exec, -1
CD_P22:
    s_waitcnt lgkmcnt(3)
    v_exp_f32 v88, v88
    s_setprio 1
    v_exp_f32 v89, v89
    v_exp_f32 v90, v90
    v_exp_f32 v91, v91
    v_smfmac_f32_32x32x32_bf16 v[176:191], v[128:131], v[72:79], v152
    v_exp_f32 v92, v92
    v_exp_f32 v93, v93
    v_exp_f32 v94, v94
    v_exp_f32 v95, v95
    v_mfma_f32_32x32x16_bf16 v[64:79], v[24:27], v[8:11], v[48:63]
    v_exp_f32 v96, v96
    v_exp_f32 v97, v97
    v_exp_f32 v98, v98
    v_exp_f32 v99, v99
    v_smfmac_f32_32x32x32_bf16 v[176:191], v[124:127], v[88:95], v152
    v_exp_f32 v100, v100
    v_exp_f32 v101, v101
    v_exp_f32 v102, v102
    s_setprio 0
    v_exp_f32 v103, v103
    ds_read_b128 v[24:27], v153 offset:53248
    s_mov_b64 exec, s[56:57]
    ds_read_b128 v[128:131], v153 offset:50432
    ds_read_b128 v[124:127], v153 offset:52224
    s_mov_b64 exec, -1
CD_P23:
    s_waitcnt lgkmcnt(3)
    v_exp_f32 v64, v64
    s_setprio 1
    v_exp_f32 v65, v65
    v_exp_f32 v66, v66
    v_exp_f32 v67, v67
    v_smfmac_f32_32x32x32_bf16 v[176:191], v[132:135], v[96:103], v152
    v_exp_f32 v68, v68
    v_exp_f32 v69, v69
    v_exp_f32 v70, v70
    v_exp_f32 v71, v71
    v_mfma_f32_32x32x16_bf16 v[88:103], v[28:31], v[8:11], v[48:63]
    v_exp_f32 v72, v72
    v_exp_f32 v73, v73
    v_exp_f32 v74, v74
    v_exp_f32 v75, v75
    v_smfmac_f32_32x32x32_bf16 v[176:191], v[120:123], v[64:71], v152
    v_exp_f32 v76, v76
    v_exp_f32 v77, v77
    v_exp_f32 v78, v78
    v_add_u32 v153, 49152, v153
    s_setprio 0
    v_exp_f32 v79, v79
    ds_read_b128 v[28:31], v153 offset:6144
    s_mov_b64 exec, s[56:57]
    ds_read_b128 v[132:135], v153 offset:3328
    ds_read_b128 v[120:123], v153 offset:5120
    s_mov_b64 exec, -1
    s_cmp_eq_u32 s25, 0
    s_cbranch_scc1 Ldf_26
    buffer_store_dwordx4 v[224:227], v241, s[32:35], s28 offen sc1
    s_add_u32 s28, s28, s29
Ldf_26:
CD_P24:
    s_branch SK_P24
.p2align 12
PG_P24:
    s_setpc_b64 s[100:101]
SK_P24:
    s_waitcnt lgkmcnt(3)
    v_exp_f32 v88, v88
    s_setprio 1
    v_exp_f32 v89, v89
    v_exp_f32 v90, v90
    v_exp_f32 v91, v91
    v_smfmac_f32_32x32x32_bf16 v[176:191], v[128:131], v[72:79], v152
    v_exp_f32 v92, v92
    v_exp_f32 v93, v93
    v_exp_f32 v94, v94
    v_exp_f32 v95, v95
    v_mfma_f32_32x32x16_bf16 v[64:79], v[24:27], v[8:11], v[48:63]
    v_exp_f32 v96, v96
    v_exp_f32 v97, v97
    v_exp_f32 v98, v98
    v_exp_f32 v99, v99
    v_smfmac_f32_32x32x32_bf16 v[176:191], v[124:127], v[88:95], v152
    v_exp_f32 v100, v100
    v_exp_f32 v101, v101
    v_exp_f32 v102, v102
    s_setprio 0
    v_exp_f32 v103, v103
    ds_read_b128 v[24:27], v153 offset:8192
    s_mov_b64 exec, s[56:57]
    ds_read_b128 v[128:131], v153 offset:5376
    ds_read_b128 v[124:127], v153 offset:7168
    s_mov_b64 exec, -1
    s_cmp_eq_u32 s25, 0
    s_cbranch_scc1 Ldf_27
    buffer_store_dwordx4 v[228:231], v241, s[32:35], s28 offen sc1
    s_add_u32 s28, s28, s30
Ldf_27:
CD_P25:
    s_waitcnt lgkmcnt(3)
    v_exp_f32 v64, v64
    s_setprio 1
    v_exp_f32 v65, v65
    v_exp_f32 v66, v66
    v_exp_f32 v67, v67
    v_smfmac_f32_32x32x32_bf16 v[176:191], v[132:135], v[96:103], v152
    v_exp_f32 v68, v68
    v_exp_f32 v69, v69
    v_exp_f32 v70, v70
    v_exp_f32 v71, v71
    v_mfma_f32_32x32x16_bf16 v[88:103], v[28:31], v[8:11], v[48:63]
    v_exp_f32 v72, v72
    v_exp_f32 v73, v73
    v_exp_f32 v74, v74
    v_exp_f32 v75, v75
    v_smfmac_f32_32x32x32_bf16 v[176:191], v[120:123], v[64:71], v152
    v_exp_f32 v76, v76
    v_exp_f32 v77, v77
    v_exp_f32 v78, v78
    s_setprio 0
    v_exp_f32 v79, v79
    ds_read_b128 v[28:31], v153 offset:10240
    s_mov_b64 exec, s[56:57]
    ds_read_b128 v[132:135], v153 offset:7424
    ds_read_b128 v[120:123], v153 offset:9216
    s_mov_b64 exec, -1
    s_cmp_eq_u32 s25, 0
    s_cbranch_scc1 Ldf_28
    buffer_store_dwordx4 v[232:235], v241, s[32:35], s28 offen sc1
    s_add_u32 s28, s28, s29
Ldf_28:
CD_P26:
    s_waitcnt lgkmcnt(3)
    v_exp_f32 v88, v88
    s_setprio 1
    v_exp_f32 v89, v89
    v_exp_f32 v90, v90
    v_exp_f32 v91, v91
    v_smfmac_f32_32x32x32_bf16 v[176:191], v[128:131], v[72:79], v152
    v_exp_f32 v92, v92
    v_exp_f32 v93, v93
    v_exp_f32 v94, v94
    v_exp_f32 v95, v95
    v_mfma_f32_32x32x16_bf16 v[64:79], v[24:27], v[8:11], v[48:63]
    v_exp_f32 v96, v96
    v_exp_f32 v97, v97
    v_exp_f32 v98, v98
    v_exp_f32 v99, v99
    v_smfmac_f32_32x32x32_bf16 v[176:191], v[124:127], v[88:95], v152
    v_exp_f32 v100, v100
    v_exp_f32 v101, v101
    v_exp_f32 v102, v102
    s_setprio 0
    v_exp_f32 v103, v103
    ds_read_b128 v[24:27], v153 offset:12288
    s_mov_b64 exec, s[56:57]
    ds_read_b128 v[128:131], v153 offset:9472
    ds_read_b128 v[124:127], v153 offset:11264
    s_mov_b64 exec, -1
    s_cmp_eq_u32 s25, 0
    s_cbranch_scc1 Ldf_29
    buffer_store_dwordx4 v[236:239], v241, s[32:35], s28 offen sc1
    s_add_u32 s28, s28, s30
Ldf_29:
CD_P27:
    s_waitcnt lgkmcnt(3)
    v_exp_f32 v64, v64
    s_setprio 1
    v_exp_f32 v65, v65
    v_exp_f32 v66, v66
    v_exp_f32 v67, v67
    v_smfmac_f32_32x32x32_bf16 v[176:191], v[132:135], v[96:103], v152
    v_exp_f32 v68, v68
    v_exp_f32 v69, v69
    v_exp_f32 v70, v70
    v_exp_f32 v71, v71
    v_mfma_f32_32x32x16_bf16 v[88:103], v[28:31], v[8:11], v[48:63]
    v_exp_f32 v72, v72
    v_exp_f32 v73, v73
    v_exp_f32 v74, v74
    v_exp_f32 v75, v75
    v_smfmac_f32_32x32x32_bf16 v[176:191], v[120:123], v[64:71], v152
    v_exp_f32 v76, v76
    v_exp_f32 v77, v77
    v_exp_f32 v78, v78
    s_setprio 0
    v_exp_f32 v79, v79
    ds_read_b128 v[28:31], v153 offset:14336
    s_mov_b64 exec, s[56:57]
    ds_read_b128 v[132:135], v153 offset:11520
    ds_read_b128 v[120:123], v153 offset:13312
    s_mov_b64 exec, -1
    s_cmp_lg_u32 s25, 2
    s_cbranch_scc1 Ldg_30
    s_mov_b32 exec_hi, 0
    buffer_store_dword v240, v242, s[32:35], s24 offen sc1
    s_mov_b64 exec, -1
Ldg_30:
CD_P28:
    s_waitcnt lgkmcnt(3)
    v_exp_f32 v88, v88
    s_setprio 1
    v_exp_f32 v89, v89
    v_exp_f32 v90, v90
    v_exp_f32 v91, v91
    v_smfmac_f32_32x32x32_bf16 v[176:191], v[128:131], v[72:79], v152
    v_exp_f32 v92, v92
    v_exp_f32 v93, v93
    v_exp_f32 v94, v94
    v_exp_f32 v95, v95
    v_mfma_f32_32x32x16_bf16 v[64:79], v[24:27], v[8:11], v[48:63]
    v_exp_f32 v96, v96
    v_exp_f32 v97, v97
    v_exp_f32 v98, v98
    v_exp_f32 v99, v99
    v_smfmac_f32_32x32x32_bf16 v[176:191], v[124:127], v[88:95], v152
    v_exp_f32 v100, v100
    v_exp_f32 v101, v101
    v_exp_f32 v102, v102
    s_setprio 0
    v_exp_f32 v103, v103
    ds_read_b128 v[24:27], v153 offset:16384
    s_mov_b64 exec, s[56:57]
    ds_read_b128 v[128:131], v153 offset:13568
    ds_read_b128 v[124:127], v153 offset:15360
    s_mov_b64 exec, -1
    buffer_store_dwordx4 v[116:119], v2, s[32:35], s14 offen sc1
CD_P29:
    s_waitcnt lgkmcnt(3)
    v_exp_f32 v64, v64
    s_setprio 1
    v_exp_f32 v65, v65
    v_exp_f32 v66, v66
    v_exp_f32 v67, v67
    v_smfmac_f32_32x32x32_bf16 v[176:191], v[132:135], v[96:103], v152
    v_exp_f32 v68, v68
    v_exp_f32 v69, v69
    v_exp_f32 v70, v70
    v_exp_f32 v71, v71
    v_mfma_f32_32x32x16_bf16 v[88:103], v[28:31], v[8:11], v[48:63]
    v_exp_f32 v72, v72
    v_exp_f32 v73, v73
    v_exp_f32 v74, v74
    v_exp_f32 v75, v75
    v_smfmac_f32_32x32x32_bf16 v[176:191], v[120:123], v[64:71], v152
    v_exp_f32 v76, v76
    v_exp_f32 v77, v77
    v_exp_f32 v78, v78
    s_setprio 0
    v_exp_f32 v79, v79
    ds_read_b128 v[28:31], v153 offset:18432
    s_mov_b64 exec, s[56:57]
    ds_read_b128 v[132:135], v153 offset:15616
    ds_read_b128 v[120:123], v153 offset:17408
    s_mov_b64 exec, -1
    buffer_store_dwordx4 v[116:119], v2, s[32:35], s15 offen sc1
CD_P30:
    s_waitcnt lgkmcnt(3)
    v_exp_f32 v88, v88
    s_setprio 1
    v_exp_f32 v89, v89
    v_exp_f32 v90, v90
    v_exp_f32 v91, v91
    v_smfmac_f32_32x32x32_bf16 v[176:191], v[128:131], v[72:79], v152
    v_exp_f32 v92, v92
    v_exp_f32 v93, v93
    v_exp_f32 v94, v94
    v_exp_f32 v95, v95
    v_mfma_f32_32x32x16_bf16 v[64:79], v[24:27], v[8:11], v[48:63]
    v_exp_f32 v96, v96
    v_exp_f32 v97, v97
    v_exp_f32 v98, v98
    v_exp_f32 v99, v99
    v_smfmac_f32_32x32x32_bf16 v[176:191], v[124:127], v[88:95], v152
    v_exp_f32 v100, v100
    v_exp_f32 v101, v101
    v_exp_f32 v102, v102
    s_setprio 0
    v_exp_f32 v103, v103
    ds_read_b128 v[24:27], v153 offset:20480
    s_mov_b64 exec, s[56:57]
    ds_read_b128 v[128:131], v153 offset:17664
    ds_read_b128 v[124:127], v153 offset:19456
    s_mov_b64 exec, -1
CD_P31:
    s_waitcnt lgkmcnt(3)
    v_exp_f32 v64, v64
    s_setprio 1
    v_exp_f32 v65, v65
    v_exp_f32 v66, v66
    v_exp_f32 v67, v67
    v_smfmac_f32_32x32x32_bf16 v[176:191], v[132:135], v[96:103], v152
    v_exp_f32 v68, v68
    v_exp_f32 v69, v69
    v_exp_f32 v70, v70
    v_exp_f32 v71, v71
    v_mfma_f32_32x32x16_bf16 v[88:103], v[28:31], v[8:11], v[48:63]
    v_exp_f32 v72, v72
    v_exp_f32 v73, v73
    v_exp_f32 v74, v74
    v_exp_f32 v75, v75
    v_smfmac_f32_32x32x32_bf16 v[176:191], v[120:123], v[64:71], v152
    v_exp_f32 v76, v76
    v_exp_f32 v77, v77
    v_exp_f32 v78, v78
    s_setprio 0
    v_exp_f32 v79, v79
    ds_read_b128 v[28:31], v153 offset:22528
    s_mov_b64 exec, s[56:57]
    ds_read_b128 v[132:135], v153 offset:19712
    ds_read_b128 v[120:123], v153 offset:21504
    s_mov_b64 exec, -1
CD_P32:
    s_waitcnt lgkmcnt(3)
    v_exp_f32 v88, v88
    s_setprio 1
    v_exp_f32 v89, v89
    v_exp_f32 v90, v90
    v_exp_f32 v91, v91
    v_smfmac_f32_32x32x32_bf16 v[176:191], v[128:131], v[72:79], v152
    v_exp_f32 v92, v92
    v_exp_f32 v93, v93
    v_exp_f32 v94, v94
    v_exp_f32 v95, v95
    v_mfma_f32_32x32x16_bf16 v[64:79], v[24:27], v[8:11], v[48:63]
    v_exp_f32 v96, v96
    v_exp_f32 v97, v97
    v_exp_f32 v98, v98
    v_exp_f32 v99, v99
    v_smfmac_f32_32x32x32_bf16 v[176:191], v[124:127], v[88:95], v152
    v_exp_f32 v100, v100
    v_exp_f32 v101, v101
    v_exp_f32 v102, v102
    s_setprio 0
    v_exp_f32 v103, v103
    ds_read_b128 v[24:27], v153 offset:24576
    s_mov_b64 exec, s[56:57]
    ds_read_b128 v[128:131], v153 offset:21760
    ds_read_b128 v[124:127], v153 offset:23552
    s_mov_b64 exec, -1
CD_P33:
    s_waitcnt lgkmcnt(3)
    v_exp_f32 v64, v64
    s_setprio 1
    v_exp_f32 v65, v65
    v_exp_f32 v66, v66
    v_exp_f32 v67, v67
    v_smfmac_f32_32x32x32_bf16 v[176:191], v[132:135], v[96:103], v152
    v_exp_f32 v68, v68
    v_exp_f32 v69, v69
    v_exp_f32 v70, v70
    v_exp_f32 v71, v71
    v_mfma_f32_32x32x16_bf16 v[88:103], v[28:31], v[8:11], v[48:63]
    v_exp_f32 v72, v72
    v_exp_f32 v73, v73
    v_exp_f32 v74, v74
    v_exp_f32 v75, v75
    v_smfmac_f32_32x32x32_bf16 v[176:191], v[120:123], v[64:71], v152
    v_exp_f32 v76, v76
    v_exp_f32 v77, v77
    v_exp_f32 v78, v78
    s_setprio 0
    v_exp_f32 v79, v79
    ds_read_b128 v[28:31], v153 offset:26624
    s_mov_b64 exec, s[56:57]
    ds_read_b128 v[132:135], v153 offset:23808
    ds_read_b128 v[120:123], v153 offset:25600
    s_mov_b64 exec, -1
CD_P34:
    s_waitcnt lgkmcnt(3)
    v_exp_f32 v88, v88
    s_setprio 1
    v_exp_f32 v89, v89
    v_exp_f32 v90, v90
    v_exp_f32 v91, v91
    v_smfmac_f32_32x32x32_bf16 v[176:191], v[128:131], v[72:79], v152
    v_exp_f32 v92, v92
    v_exp_f32 v93, v93
    v_exp_f32 v94, v94
    v_exp_f32 v95, v95
    v_mfma_f32_32x32x16_bf16 v[64:79], v[24:27], v[8:11], v[48:63]
    v_exp_f32 v96, v96
    v_exp_f32 v97, v97
    v_exp_f32 v98, v98
    v_exp_f32 v99, v99
    v_smfmac_f32_32x32x32_bf16 v[176:191], v[124:127], v[88:95], v152
    v_exp_f32 v100, v100
    v_exp_f32 v101, v101
    v_exp_f32 v102, v102
    s_setprio 0
    v_exp_f32 v103, v103
    ds_read_b128 v[24:27], v153 offset:28672
    s_mov_b64 exec, s[56:57]
    ds_read_b128 v[128:131], v153 offset:25856
    ds_read_b128 v[124:127], v153 offset:27648
    s_mov_b64 exec, -1
CD_P35:
    s_waitcnt lgkmcnt(3)
    v_exp_f32 v64, v64
    s_setprio 1
    v_exp_f32 v65, v65
    v_exp_f32 v66, v66
    v_exp_f32 v67, v67
    v_smfmac_f32_32x32x32_bf16 v[176:191], v[132:135], v[96:103], v152
    v_exp_f32 v68, v68
    v_exp_f32 v69, v69
    v_exp_f32 v70, v70
    v_exp_f32 v71, v71
    v_mfma_f32_32x32x16_bf16 v[88:103], v[28:31], v[8:11], v[48:63]
    v_exp_f32 v72, v72
    v_exp_f32 v73, v73
    v_exp_f32 v74, v74
    v_exp_f32 v75, v75
    v_smfmac_f32_32x32x32_bf16 v[176:191], v[120:123], v[64:71], v152
    v_exp_f32 v76, v76
    v_exp_f32 v77, v77
    v_exp_f32 v78, v78
    s_setprio 0
    v_exp_f32 v79, v79
    ds_read_b128 v[28:31], v153 offset:30720
    s_mov_b64 exec, s[56:57]
    ds_read_b128 v[132:135], v153 offset:27904
    ds_read_b128 v[120:123], v153 offset:29696
    s_mov_b64 exec, -1
CD_P36:
    s_waitcnt lgkmcnt(3)
    v_exp_f32 v88, v88
    s_setprio 1
    v_exp_f32 v89, v89
    v_exp_f32 v90, v90
    v_exp_f32 v91, v91
    v_smfmac_f32_32x32x32_bf16 v[176:191], v[128:131], v[72:79], v152
    v_exp_f32 v92, v92
    v_exp_f32 v93, v93
    v_exp_f32 v94, v94
    v_exp_f32 v95, v95
    v_mfma_f32_32x32x16_bf16 v[64:79], v[24:27], v[8:11], v[48:63]
    v_exp_f32 v96, v96
    v_exp_f32 v97, v97
    v_exp_f32 v98, v98
    v_exp_f32 v99, v99
    v_smfmac_f32_32x32x32_bf16 v[176:191], v[124:127], v[88:95], v152
    v_exp_f32 v100, v100
    v_exp_f32 v101, v101
    v_exp_f32 v102, v102
    s_setprio 0
    v_exp_f32 v103, v103
    ds_read_b128 v[24:27], v153 offset:32768
    s_mov_b64 exec, s[56:57]
    ds_read_b128 v[128:131], v153 offset:29952
    ds_read_b128 v[124:127], v153 offset:31744
    s_mov_b64 exec, -1
CD_P37:
    s_waitcnt lgkmcnt(3)
    v_exp_f32 v64, v64
    s_setprio 1
    v_exp_f32 v65, v65
    v_exp_f32 v66, v66
    v_exp_f32 v67, v67
    v_smfmac_f32_32x32x32_bf16 v[176:191], v[132:135], v[96:103], v152
    v_exp_f32 v68, v68
    v_exp_f32 v69, v69
    v_exp_f32 v70, v70
    v_exp_f32 v71, v71
    v_mfma_f32_32x32x16_bf16 v[88:103], v[28:31], v[8:11], v[48:63]
    v_exp_f32 v72, v72
    v_exp_f32 v73, v73
    v_exp_f32 v74, v74
    v_exp_f32 v75, v75
    v_smfmac_f32_32x32x32_bf16 v[176:191], v[120:123], v[64:71], v152
    v_exp_f32 v76, v76
    v_exp_f32 v77, v77
    v_exp_f32 v78, v78
    s_setprio 0
    v_exp_f32 v79, v79
    ds_read_b128 v[28:31], v153 offset:34816
    s_mov_b64 exec, s[56:57]
    ds_read_b128 v[132:135], v153 offset:32000
    ds_read_b128 v[120:123], v153 offset:33792
    s_mov_b64 exec, -1
    s_waitcnt vmcnt(0)
    s_mov_b64 exec, 1
    buffer_store_dwordx2 v[112:113], v114, s[32:35], s11 offen sc1
    s_cmp_eq_u32 s25, 0
    s_cbranch_scc1 Lfb_33
    buffer_store_dwordx2 v[112:113], v114, s[32:35], s31 offen sc1
Lfb_33:
    s_mov_b64 exec, -1
CD_P38:
    s_waitcnt lgkmcnt(3)
    v_exp_f32 v88, v88
    s_setprio 1
    v_exp_f32 v89, v89
    v_exp_f32 v90, v90
    v_exp_f32 v91, v91
    v_smfmac_f32_32x32x32_bf16 v[176:191], v[128:131], v[72:79], v152
    v_exp_f32 v92, v92
    v_exp_f32 v93, v93
    v_exp_f32 v94, v94
    v_exp_f32 v95, v95
    v_mfma_f32_32x32x16_bf16 v[64:79], v[24:27], v[8:11], v[48:63]
    v_exp_f32 v96, v96
    v_exp_f32 v97, v97
    v_exp_f32 v98, v98
    v_exp_f32 v99, v99
    v_smfmac_f32_32x32x32_bf16 v[176:191], v[124:127], v[88:95], v152
    v_exp_f32 v100, v100
    v_exp_f32 v101, v101
    v_exp_f32 v102, v102
    s_setprio 0
    v_exp_f32 v103, v103
    ds_read_b128 v[24:27], v153 offset:36864
    s_mov_b64 exec, s[56:57]
    ds_read_b128 v[128:131], v153 offset:34048
    ds_read_b128 v[124:127], v153 offset:35840
    s_mov_b64 exec, -1
    s_add_u32 m0, s18, 0
    s_add_u32 s58, s23, 0
    buffer_load_dwordx4 v244, s[40:43], s58 offen lds
CD_P39:
    s_waitcnt lgkmcnt(3)
    v_exp_f32 v64, v64
    s_setprio 1
    v_exp_f32 v65, v65
    v_exp_f32 v66, v66
    v_exp_f32 v67, v67
    v_smfmac_f32_32x32x32_bf16 v[176:191], v[132:135], v[96:103], v152
    v_exp_f32 v68, v68
    v_exp_f32 v69, v69
    v_exp_f32 v70, v70
    v_exp_f32 v71, v71
    v_mfma_f32_32x32x16_bf16 v[88:103], v[28:31], v[8:11], v[48:63]
    v_exp_f32 v72, v72
    v_exp_f32 v73, v73
    v_exp_f32 v74, v74
    v_exp_f32 v75, v75
    v_smfmac_f32_32x32x32_bf16 v[176:191], v[120:123], v[64:71], v152
    v_exp_f32 v76, v76
    v_exp_f32 v77, v77
    v_exp_f32 v78, v78
    s_setprio 0
    v_exp_f32 v79, v79
    ds_read_b128 v[28:31], v153 offset:38912
    s_mov_b64 exec, s[56:57]
    ds_read_b128 v[132:135], v153 offset:36096
    ds_read_b128 v[120:123], v153 offset:37888
    s_mov_b64 exec, -1
    s_add_u32 m0, s18, 8192
    s_add_u32 s58, s23, 65536
    buffer_load_dwordx4 v244, s[40:43], s58 offen lds
CD_P40:
    s_waitcnt lgkmcnt(3)
    v_exp_f32 v88, v88
    s_setprio 1
    v_exp_f32 v89, v89
    v_exp_f32 v90, v90
    v_exp_f32 v91, v91
    v_smfmac_f32_32x32x32_bf16 v[176:191], v[128:131], v[72:79], v152
    v_exp_f32 v92, v92
    v_exp_f32 v93, v93
    v_exp_f32 v94, v94
    v_exp_f32 v95, v95
    v_mfma_f32_32x32x16_bf16 v[64:79], v[24:27], v[8:11], v[48:63]
    v_exp_f32 v96, v96
    v_exp_f32 v97, v97
    v_exp_f32 v98, v98
    v_exp_f32 v99, v99
    v_smfmac_f32_32x32x32_bf16 v[176:191], v[124:127], v[88:95], v152
    v_exp_f32 v100, v100
    v_exp_f32 v101, v101
    v_exp_f32 v102, v102
    s_setprio 0
    v_exp_f32 v103, v103
    ds_read_b128 v[24:27], v153 offset:40960
    s_mov_b64 exec, s[56:57]
    ds_read_b128 v[128:131], v153 offset:38144
    ds_read_b128 v[124:127], v153 offset:39936
    s_mov_b64 exec, -1
    s_add_u32 m0, s18, 16384
    s_add_u32 s58, s23, 131072
    buffer_load_dwordx4 v244, s[40:43], s58 offen lds
CD_P41:
    s_waitcnt lgkmcnt(3)
    v_exp_f32 v64, v64
    s_setprio 1
    v_exp_f32 v65, v65
    v_exp_f32 v66, v66
    v_exp_f32 v67, v67
    v_smfmac_f32_32x32x32_bf16 v[176:191], v[132:135], v[96:103], v152
    v_exp_f32 v68, v68
    v_exp_f32 v69, v69
    v_exp_f32 v70, v70
    v_exp_f32 v71, v71
    v_mfma_f32_32x32x16_bf16 v[88:103], v[28:31], v[8:11], v[48:63]
    v_exp_f32 v72, v72
    v_exp_f32 v73, v73
    v_exp_f32 v74, v74
    v_exp_f32 v75, v75
    v_smfmac_f32_32x32x32_bf16 v[176:191], v[120:123], v[64:71], v152
    v_exp_f32 v76, v76
    v_exp_f32 v77, v77
    v_exp_f32 v78, v78
    s_setprio 0
    v_exp_f32 v79, v79
    ds_read_b128 v[28:31], v153 offset:43008
    s_mov_b64 exec, s[56:57]
    ds_read_b128 v[132:135], v153 offset:40192
    ds_read_b128 v[120:123], v153 offset:41984
    s_mov_b64 exec, -1
    s_add_u32 m0, s18, 24576
    s_add_u32 s58, s23, 196608
    buffer_load_dwordx4 v244, s[40:43], s58 offen lds
CD_P42:
    s_waitcnt lgkmcnt(3)
    v_exp_f32 v88, v88
    s_setprio 1
    v_exp_f32 v89, v89
    v_exp_f32 v90, v90
    v_exp_f32 v91, v91
    v_smfmac_f32_32x32x32_bf16 v[176:191], v[128:131], v[72:79], v152
    v_exp_f32 v92, v92
    v_exp_f32 v93, v93
    v_exp_f32 v94, v94
    v_exp_f32 v95, v95
    v_mfma_f32_32x32x16_bf16 v[64:79], v[24:27], v[8:11], v[48:63]
    v_exp_f32 v96, v96
    v_exp_f32 v97, v97
    v_exp_f32 v98, v98
    v_exp_f32 v99, v99
    v_smfmac_f32_32x32x32_bf16 v[176:191], v[124:127], v[88:95], v152
    v_exp_f32 v100, v100
    v_exp_f32 v101, v101
    v_exp_f32 v102, v102
    s_setprio 0
    v_exp_f32 v103, v103
    ds_read_b128 v[24:27], v153 offset:45056
    s_mov_b64 exec, s[56:57]
    ds_read_b128 v[128:131], v153 offset:42240
    ds_read_b128 v[124:127], v153 offset:44032
    s_mov_b64 exec, -1
    s_mov_b64 exec, 0x7f0000
    buffer_load_dwordx2 v[12:13], v246, s[32:35], s21 offen sc1
    s_mov_b64 exec, -1
CD_P43:
    s_waitcnt lgkmcnt(3)
    v_exp_f32 v64, v64
    s_setprio 1
    v_exp_f32 v65, v65
    v_exp_f32 v66, v66
    v_exp_f32 v67, v67
    v_smfmac_f32_32x32x32_bf16 v[176:191], v[132:135], v[96:103], v152
    v_exp_f32 v68, v68
    v_exp_f32 v69, v69
    v_exp_f32 v70, v70
    v_exp_f32 v71, v71
    v_mfma_f32_32x32x16_bf16 v[88:103], v[28:31], v[8:11], v[48:63]
    v_exp_f32 v72, v72
    v_exp_f32 v73, v73
    v_exp_f32 v74, v74
    v_exp_f32 v75, v75
    v_smfmac_f32_32x32x32_bf16 v[176:191], v[120:123], v[64:71], v152
    v_exp_f32 v76, v76
    v_exp_f32 v77, v77
    v_exp_f32 v78, v78
    s_setprio 0
    v_exp_f32 v79, v79
    ds_read_b128 v[28:31], v153 offset:47104
    s_mov_b64 exec, s[56:57]
    ds_read_b128 v[132:135], v153 offset:44288
    ds_read_b128 v[120:123], v153 offset:46080
    s_mov_b64 exec, -1
    s_mov_b64 exec, 0xff
    buffer_load_dwordx2 v[14:15], v245, s[32:35], s53 offen sc1
    s_mov_b64 exec, -1
CD_P44:
    s_waitcnt lgkmcnt(3)
    v_exp_f32 v88, v88
    s_setprio 1
    v_exp_f32 v89, v89
    v_exp_f32 v90, v90
    v_exp_f32 v91, v91
    v_smfmac_f32_32x32x32_bf16 v[176:191], v[128:131], v[72:79], v152
    v_exp_f32 v92, v92
    v_exp_f32 v93, v93
    v_exp_f32 v94, v94
    v_exp_f32 v95, v95
    v_mfma_f32_32x32x16_bf16 v[64:79], v[24:27], v[8:11], v[48:63]
    v_exp_f32 v96, v96
    v_exp_f32 v97, v97
    v_exp_f32 v98, v98
    v_exp_f32 v99, v99
    v_smfmac_f32_32x32x32_bf16 v[176:191], v[124:127], v[88:95], v152
    v_exp_f32 v100, v100
    v_exp_f32 v101, v101
    v_exp_f32 v102, v102
    s_setprio 0
    v_exp_f32 v103, v103
    ds_read_b128 v[24:27], v153 offset:49152
    s_mov_b64 exec, s[56:57]
    ds_read_b128 v[128:131], v153 offset:46336
    ds_read_b128 v[124:127], v153 offset:48128
    s_mov_b64 exec, -1
CD_P45:
    s_waitcnt lgkmcnt(3)
    v_exp_f32 v64, v64
    s_setprio 1
    v_exp_f32 v65, v65
    v_exp_f32 v66, v66
    v_exp_f32 v67, v67
    v_smfmac_f32_32x32x32_bf16 v[176:191], v[132:135], v[96:103], v152
    v_exp_f32 v68, v68
    v_exp_f32 v69, v69
    v_exp_f32 v70, v70
    v_exp_f32 v71, v71
    v_mfma_f32_32x32x16_bf16 v[88:103], v[28:31], v[8:11], v[48:63]
    v_exp_f32 v72, v72
    v_exp_f32 v73, v73
    v_exp_f32 v74, v74
    v_exp_f32 v75, v75
    v_smfmac_f32_32x32x32_bf16 v[176:191], v[120:123], v[64:71], v152
    v_exp_f32 v76, v76
    v_exp_f32 v77, v77
    v_exp_f32 v78, v78
    s_setprio 0
    v_exp_f32 v79, v79
    ds_read_b128 v[28:31], v153 offset:51200
    s_mov_b64 exec, s[56:57]
    ds_read_b128 v[132:135], v153 offset:48384
    ds_read_b128 v[120:123], v153 offset:50176
    s_mov_b64 exec, -1
    s_waitcnt vmcnt(0)
CD_P46:
    s_waitcnt lgkmcnt(3)
    v_exp_f32 v88, v88
    s_setprio 1
    v_exp_f32 v89, v89
    v_exp_f32 v90, v90
    v_exp_f32 v91, v91
    v_smfmac_f32_32x32x32_bf16 v[176:191], v[128:131], v[72:79], v152
    v_exp_f32 v92, v92
    v_exp_f32 v93, v93
    v_exp_f32 v94, v94
    v_exp_f32 v95, v95
    v_mfma_f32_32x32x16_bf16 v[64:79], v[24:27], v[8:11], v[48:63]
    v_exp_f32 v96, v96
    v_exp_f32 v97, v97
    v_exp_f32 v98, v98
    v_exp_f32 v99, v99
    v_smfmac_f32_32x32x32_bf16 v[176:191], v[124:127], v[88:95], v152
    v_exp_f32 v100, v100
    v_exp_f32 v101, v101
    v_exp_f32 v102, v102
    v_cmp_ne_u64 vcc, s[12:13], v[12:13]
    s_setprio 0
    v_exp_f32 v103, v103
    s_and_b32 s58, vcc_lo, 0x7f0000
    s_cbranch_scc1 LF3_34
LF3d_35:
    ds_read_b128 v[24:27], v153 offset:53248
    s_mov_b64 exec, s[56:57]
    ds_read_b128 v[128:131], v153 offset:50432
    ds_read_b128 v[124:127], v153 offset:52224
    s_mov_b64 exec, -1
    s_lshl_b32 s59, s3, 12
    s_add_u32 m0, s59, 131072
    s_cmp_eq_u32 s3, 0
    s_cselect_b32 exec_lo, -2, -1
    s_mov_b32 exec_hi, exec_lo
    buffer_load_dwordx4 v2, s[32:35], s20 offen sc1 lds
    s_mov_b64 exec, -1
CD_P47:
    s_waitcnt lgkmcnt(3)
    v_exp_f32 v64, v64
    s_setprio 1
    v_exp_f32 v65, v65
    v_exp_f32 v66, v66
    v_exp_f32 v67, v67
    v_smfmac_f32_32x32x32_bf16 v[176:191], v[132:135], v[96:103], v152
    v_exp_f32 v68, v68
    v_exp_f32 v69, v69
    v_exp_f32 v70, v70
    v_exp_f32 v71, v71
    v_mfma_f32_32x32x16_bf16 v[88:103], v[28:31], v[8:11], v[48:63]
    v_exp_f32 v72, v72
    v_exp_f32 v73, v73
    v_exp_f32 v74, v74
    v_exp_f32 v75, v75
    v_smfmac_f32_32x32x32_bf16 v[176:191], v[120:123], v[64:71], v152
    v_exp_f32 v76, v76
    v_exp_f32 v77, v77
    v_exp_f32 v78, v78
    v_add_u32 v153, 49152, v153
    s_setprio 0
    v_exp_f32 v79, v79
    ds_read_b128 v[28:31], v153 offset:6144
    s_mov_b64 exec, s[56:57]
    ds_read_b128 v[132:135], v153 offset:3328
    ds_read_b128 v[120:123], v153 offset:5120
    s_mov_b64 exec, -1
    buffer_load_dwordx4 v2, s[32:35], s20 offen offset:1024 sc1 lds
    buffer_load_dwordx4 v2, s[32:35], s20 offen offset:2048 sc1 lds
CD_P48:
    s_waitcnt lgkmcnt(3)
    v_exp_f32 v88, v88
    s_setprio 1
    v_exp_f32 v89, v89
    v_exp_f32 v90, v90
    v_exp_f32 v91, v91
    v_smfmac_f32_32x32x32_bf16 v[176:191], v[128:131], v[72:79], v152
    v_exp_f32 v92, v92
    v_exp_f32 v93, v93
    v_exp_f32 v94, v94
    v_exp_f32 v95, v95
    v_mfma_f32_32x32x16_bf16 v[64:79], v[24:27], v[8:11], v[48:63]
    v_exp_f32 v96, v96
    v_exp_f32 v97, v97
    v_exp_f32 v98, v98
    v_exp_f32 v99, v99
    v_smfmac_f32_32x32x32_bf16 v[176:191], v[124:127], v[88:95], v152
    v_exp_f32 v100, v100
    v_exp_f32 v101, v101
    v_exp_f32 v102, v102
    s_setprio 0
    v_exp_f32 v103, v103
    ds_read_b128 v[24:27], v153 offset:8192
    s_mov_b64 exec, s[56:57]
    ds_read_b128 v[128:131], v153 offset:5376
    ds_read_b128 v[124:127], v153 offset:7168
    s_mov_b64 exec, -1
    buffer_load_dwordx4 v2, s[32:35], s20 offen offset:3072 sc1 lds
    s_lshl_b32 s59, s8, 6
    s_add_u32 s59, s59, s10
    s_lshl_b32 s59, s59, 10
    buffer_load_dwordx4 v[4:7], v2, s[32:35], s59 offen sc1
CD_P49:
    s_waitcnt lgkmcnt(3)
    v_exp_f32 v64, v64
    s_setprio 1
    v_exp_f32 v65, v65
    v_exp_f32 v66, v66
    v_exp_f32 v67, v67
    v_smfmac_f32_32x32x32_bf16 v[176:191], v[132:135], v[96:103], v152
    v_exp_f32 v68, v68
    v_exp_f32 v69, v69
    v_exp_f32 v70, v70
    v_exp_f32 v71, v71
    v_mfma_f32_32x32x16_bf16 v[88:103], v[28:31], v[8:11], v[48:63]
    v_exp_f32 v72, v72
    v_exp_f32 v73, v73
    v_exp_f32 v74, v74
    v_exp_f32 v75, v75
    v_smfmac_f32_32x32x32_bf16 v[176:191], v[120:123], v[64:71], v152
    v_exp_f32 v76, v76
    v_exp_f32 v77, v77
    v_exp_f32 v78, v78
    s_setprio 0
    v_exp_f32 v79, v79
    ds_read_b128 v[28:31], v153 offset:10240
    s_mov_b64 exec, s[56:57]
    ds_read_b128 v[132:135], v153 offset:7424
    ds_read_b128 v[120:123], v153 offset:9216
    s_mov_b64 exec, -1
    s_lshl_b32 s58, s5, 13
    s_lshl_b32 s59, s10, 7
    s_add_u32 s58, s58, s59
    s_add_u32 s58, s58, 0x1000000
    buffer_load_dword v155, v115, s[32:35], s58 offen sc1
    s_add_u32 s58, s58, 0x10000
    buffer_load_dword v111, v115, s[32:35], s58 offen sc1
CD_P50:
    s_waitcnt lgkmcnt(3)
    v_exp_f32 v88, v88
    s_setprio 1
    v_exp_f32 v89, v89
    v_exp_f32 v90, v90
    v_exp_f32 v91, v91
    v_smfmac_f32_32x32x32_bf16 v[176:191], v[128:131], v[72:79], v152
    v_exp_f32 v92, v92
    v_exp_f32 v93, v93
    v_exp_f32 v94, v94
    v_exp_f32 v95, v95
    v_mfma_f32_32x32x16_bf16 v[64:79], v[24:27], v[8:11], v[48:63]
    v_exp_f32 v96, v96
    v_exp_f32 v97, v97
    v_exp_f32 v98, v98
    v_exp_f32 v99, v99
    v_smfmac_f32_32x32x32_bf16 v[176:191], v[124:127], v[88:95], v152
    v_exp_f32 v100, v100
    v_exp_f32 v101, v101
    v_exp_f32 v102, v102
    s_setprio 0
    v_exp_f32 v103, v103
    ds_read_b128 v[24:27], v153 offset:12288
    s_mov_b64 exec, s[56:57]
    ds_read_b128 v[128:131], v153 offset:9472
    ds_read_b128 v[124:127], v153 offset:11264
    s_mov_b64 exec, -1
    s_nop 0
CD_P51:
    s_branch SK_P51
.p2align 12
PG_P51:
    s_setpc_b64 s[100:101]
SK_P51:
    s_waitcnt lgkmcnt(3)
    v_exp_f32 v64, v64
    s_setprio 1
    v_exp_f32 v65, v65
    v_exp_f32 v66, v66
    v_exp_f32 v67, v67
    v_smfmac_f32_32x32x32_bf16 v[176:191], v[132:135], v[96:103], v152
    v_exp_f32 v68, v68
    v_exp_f32 v69, v69
    v_exp_f32 v70, v70
    v_exp_f32 v71, v71
    v_mfma_f32_32x32x16_bf16 v[88:103], v[28:31], v[8:11], v[48:63]
    v_exp_f32 v72, v72
    v_exp_f32 v73, v73
    v_exp_f32 v74, v74
    v_exp_f32 v75, v75
    v_smfmac_f32_32x32x32_bf16 v[176:191], v[120:123], v[64:71], v152
    v_exp_f32 v76, v76
    v_exp_f32 v77, v77
    v_exp_f32 v78, v78
    v_cmp_ne_u64 vcc, s[12:13], v[14:15]
    s_setprio 0
    v_exp_f32 v79, v79
    s_and_b32 s58, vcc_lo, 0xff
    s_cbranch_scc1 LFC_37
LFCd_38:
    ds_read_b128 v[28:31], v153 offset:14336
    s_mov_b64 exec, s[56:57]
    ds_read_b128 v[132:135], v153 offset:11520
    ds_read_b128 v[120:123], v153 offset:13312
    s_mov_b64 exec, -1
CD_P52:
    s_waitcnt lgkmcnt(3)
    v_exp_f32 v88, v88
    s_setprio 1
    v_exp_f32 v89, v89
    v_exp_f32 v90, v90
    v_exp_f32 v91, v91
    v_smfmac_f32_32x32x32_bf16 v[176:191], v[128:131], v[72:79], v152
    v_exp_f32 v92, v92
    v_exp_f32 v93, v93
    v_exp_f32 v94, v94
    v_exp_f32 v95, v95
    v_mfma_f32_32x32x16_bf16 v[64:79], v[24:27], v[8:11], v[48:63]
    v_exp_f32 v96, v96
    v_exp_f32 v97, v97
    v_exp_f32 v98, v98
    v_exp_f32 v99, v99
    v_smfmac_f32_32x32x32_bf16 v[176:191], v[124:127], v[88:95], v152
    v_exp_f32 v100, v100
    v_exp_f32 v101, v101
    v_exp_f32 v102, v102
    s_setprio 0
    v_exp_f32 v103, v103
    ds_read_b128 v[24:27], v153 offset:16384
    s_mov_b64 exec, s[56:57]
    ds_read_b128 v[128:131], v153 offset:13568
    ds_read_b128 v[124:127], v153 offset:15360
    s_mov_b64 exec, -1
CD_P53:
    s_waitcnt lgkmcnt(3)
    v_exp_f32 v64, v64
    s_setprio 1
    v_exp_f32 v65, v65
    v_exp_f32 v66, v66
    v_exp_f32 v67, v67
    v_smfmac_f32_32x32x32_bf16 v[176:191], v[132:135], v[96:103], v152
    v_exp_f32 v68, v68
    v_exp_f32 v69, v69
    v_exp_f32 v70, v70
    v_exp_f32 v71, v71
    v_mfma_f32_32x32x16_bf16 v[88:103], v[28:31], v[8:11], v[48:63]
    v_exp_f32 v72, v72
    v_exp_f32 v73, v73
    v_exp_f32 v74, v74
    v_exp_f32 v75, v75
    v_smfmac_f32_32x32x32_bf16 v[176:191], v[120:123], v[64:71], v152
    v_exp_f32 v76, v76
    v_exp_f32 v77, v77
    v_exp_f32 v78, v78
    v_add_u32 v3, 3, v110
    s_setprio 0
    v_exp_f32 v79, v79
    s_waitcnt vmcnt(0)
    ds_read_b128 v[28:31], v153 offset:18432
    ds_write_b32 v109, v3
    s_mov_b64 exec, s[56:57]
    ds_read_b128 v[132:135], v153 offset:15616
    ds_read_b128 v[120:123], v153 offset:17408
    s_mov_b64 exec, -1
CD_P54:
    s_waitcnt lgkmcnt(4)
    v_exp_f32 v88, v88
    s_setprio 1
    v_exp_f32 v89, v89
    v_exp_f32 v90, v90
    v_exp_f32 v91, v91
    v_smfmac_f32_32x32x32_bf16 v[176:191], v[128:131], v[72:79], v152
    v_exp_f32 v92, v92
    v_exp_f32 v93, v93
    v_exp_f32 v94, v94
    v_exp_f32 v95, v95
    v_mfma_f32_32x32x16_bf16 v[64:79], v[24:27], v[8:11], v[48:63]
    v_exp_f32 v96, v96
    v_exp_f32 v97, v97
    v_exp_f32 v98, v98
    v_exp_f32 v99, v99
    v_smfmac_f32_32x32x32_bf16 v[176:191], v[124:127], v[88:95], v152
    v_exp_f32 v100, v100
    v_exp_f32 v101, v101
    v_exp_f32 v102, v102
    s_setprio 0
    v_exp_f32 v103, v103
    ds_read_b128 v[24:27], v153 offset:20480
    ds_read_b32 v108, v247
    s_mov_b64 exec, s[56:57]
    ds_read_b128 v[128:131], v153 offset:17664
    ds_read_b128 v[124:127], v153 offset:19456
    s_mov_b64 exec, -1
CD_P55:
    s_waitcnt lgkmcnt(4)
    v_exp_f32 v64, v64
    s_setprio 1
    v_exp_f32 v65, v65
    v_exp_f32 v66, v66
    v_add_f32 v155, v155, v111
    v_exp_f32 v67, v67
    v_smfmac_f32_32x32x32_bf16 v[176:191], v[132:135], v[96:103], v152
    v_exp_f32 v68, v68
    v_mul_f32 v155, 0xbfb8aa3b, v155
    v_exp_f32 v69, v69
    v_exp_f32 v70, v70
    v_exp_f32 v155, v155
    v_exp_f32 v71, v71
    v_mfma_f32_32x32x16_bf16 v[88:103], v[28:31], v[8:11], v[48:63]
    v_exp_f32 v72, v72
    v_add_f32 v155, 1.0, v155
    v_exp_f32 v73, v73
    v_exp_f32 v74, v74
    v_rcp_f32 v155, v155
    v_exp_f32 v75, v75
    v_smfmac_f32_32x32x32_bf16 v[176:191], v[120:123], v[64:71], v152
    v_exp_f32 v76, v76
    v_exp_f32 v77, v77
    v_exp_f32 v78, v78
    s_setprio 0
    v_exp_f32 v79, v79
    ds_read_b128 v[28:31], v153 offset:22528
    s_mov_b64 exec, s[56:57]
    ds_read_b128 v[132:135], v153 offset:19712
    ds_read_b128 v[120:123], v153 offset:21504
    s_mov_b64 exec, -1
CD_P56:
    s_waitcnt lgkmcnt(3)
    v_exp_f32 v88, v88
    s_setprio 1
    v_exp_f32 v89, v89
    v_exp_f32 v90, v90
    v_exp_f32 v91, v91
    v_smfmac_f32_32x32x32_bf16 v[176:191], v[128:131], v[72:79], v152
    v_exp_f32 v92, v92
    v_exp_f32 v93, v93
    v_exp_f32 v94, v94
    v_exp_f32 v95, v95
    v_mfma_f32_32x32x16_bf16 v[64:79], v[24:27], v[8:11], v[48:63]
    v_exp_f32 v96, v96
    v_exp_f32 v97, v97
    v_exp_f32 v98, v98
    v_exp_f32 v99, v99
    v_smfmac_f32_32x32x32_bf16 v[176:191], v[124:127], v[88:95], v152
    v_exp_f32 v100, v100
    v_sub_u32 v108, v3, v108
    v_exp_f32 v101, v101
    v_exp_f32 v102, v102
    v_cmp_eq_u32 vcc, 1, v108
    s_setprio 0
    v_exp_f32 v103, v103
    s_cbranch_vccnz Lsy_40
Lsyd_41:
    ds_read_b128 v[24:27], v153 offset:24576
    s_mov_b64 exec, s[56:57]
    ds_read_b128 v[128:131], v153 offset:21760
    ds_read_b128 v[124:127], v153 offset:23552
    s_mov_b64 exec, -1
    s_add_u32 m0, s18, 32768
    s_add_u32 s58, s23, 262144
    buffer_load_dwordx4 v244, s[40:43], s58 offen lds
CD_P57:
    s_waitcnt lgkmcnt(3)
    v_exp_f32 v64, v64
    s_setprio 1
    v_exp_f32 v65, v65
    v_exp_f32 v66, v66
    v_exp_f32 v67, v67
    v_smfmac_f32_32x32x32_bf16 v[176:191], v[132:135], v[96:103], v152
    v_exp_f32 v68, v68
    v_exp_f32 v69, v69
    v_exp_f32 v70, v70
    v_exp_f32 v71, v71
    v_mfma_f32_32x32x16_bf16 v[88:103], v[28:31], v[8:11], v[48:63]
    v_exp_f32 v72, v72
    v_exp_f32 v73, v73
    v_exp_f32 v74, v74
    v_exp_f32 v75, v75
    v_smfmac_f32_32x32x32_bf16 v[176:191], v[120:123], v[64:71], v152
    v_exp_f32 v76, v76
    v_exp_f32 v77, v77
    v_exp_f32 v78, v78
    s_setprio 0
    v_exp_f32 v79, v79
    ds_read_b128 v[28:31], v153 offset:26624
    s_mov_b64 exec, s[56:57]
    ds_read_b128 v[132:135], v153 offset:23808
    ds_read_b128 v[120:123], v153 offset:25600
    s_mov_b64 exec, -1
    s_add_u32 m0, s18, 40960
    s_add_u32 s58, s23, 327680
    buffer_load_dwordx4 v244, s[40:43], s58 offen lds
CD_P58:
    s_waitcnt lgkmcnt(3)
    v_exp_f32 v88, v88
    s_setprio 1
    v_exp_f32 v89, v89
    v_exp_f32 v90, v90
    v_exp_f32 v91, v91
    v_smfmac_f32_32x32x32_bf16 v[176:191], v[128:131], v[72:79], v152
    v_exp_f32 v92, v92
    v_exp_f32 v93, v93
    v_exp_f32 v94, v94
    v_exp_f32 v95, v95
    v_mfma_f32_32x32x16_bf16 v[64:79], v[24:27], v[8:11], v[48:63]
    v_exp_f32 v96, v96
    v_exp_f32 v97, v97
    v_exp_f32 v98, v98
    v_exp_f32 v99, v99
    v_smfmac_f32_32x32x32_bf16 v[176:191], v[124:127], v[88:95], v152
    v_exp_f32 v100, v100
    v_exp_f32 v101, v101
    v_exp_f32 v102, v102
    s_setprio 0
    v_exp_f32 v103, v103
    ds_read_b128 v[24:27], v153 offset:28672
    ds_read_b128 v[192:195], v154 offset:16384
    s_mov_b64 exec, s[56:57]
    ds_read_b128 v[128:131], v153 offset:25856
    ds_read_b128 v[124:127], v153 offset:27648
    s_mov_b64 exec, -1
    s_add_u32 m0, s18, 49152
    s_add_u32 s58, s23, 393216
    buffer_load_dwordx4 v244, s[40:43], s58 offen lds
CD_P59:
    s_waitcnt lgkmcnt(4)
    v_exp_f32 v64, v64
    s_setprio 1
    v_exp_f32 v65, v65
    v_exp_f32 v66, v66
    v_exp_f32 v67, v67
    v_smfmac_f32_32x32x32_bf16 v[176:191], v[132:135], v[96:103], v152
    v_exp_f32 v68, v68
    v_exp_f32 v69, v69
    v_exp_f32 v70, v70
    v_exp_f32 v71, v71
    v_mfma_f32_32x32x16_bf16 v[88:103], v[28:31], v[8:11], v[48:63]
    v_exp_f32 v72, v72
    v_exp_f32 v73, v73
    v_exp_f32 v74, v74
    v_exp_f32 v75, v75
    v_smfmac_f32_32x32x32_bf16 v[176:191], v[120:123], v[64:71], v152
    v_exp_f32 v76, v76
    v_exp_f32 v77, v77
    v_exp_f32 v78, v78
    s_setprio 0
    v_exp_f32 v79, v79
    ds_read_b128 v[28:31], v153 offset:30720
    s_mov_b64 exec, s[56:57]
    ds_read_b128 v[132:135], v153 offset:27904
    ds_read_b128 v[120:123], v153 offset:29696
    s_mov_b64 exec, -1
    s_add_u32 m0, s18, 57344
    s_add_u32 s58, s23, 458752
    buffer_load_dwordx4 v244, s[40:43], s58 offen lds
CD_P60:
    s_waitcnt lgkmcnt(3)
    v_exp_f32 v88, v88
    s_setprio 1
    v_exp_f32 v89, v89
    v_mfma_f32_32x32x16_bf16 v[196:211], v[192:195], v[4:7], v[136:151]
    v_exp_f32 v90, v90
    v_exp_f32 v91, v91
    v_exp_f32 v92, v92
    v_smfmac_f32_32x32x32_bf16 v[176:191], v[128:131], v[72:79], v152
    v_exp_f32 v93, v93
    v_exp_f32 v94, v94
    v_exp_f32 v95, v95
    v_mfma_f32_32x32x16_bf16 v[64:79], v[24:27], v[8:11], v[48:63]
    v_exp_f32 v96, v96
    v_exp_f32 v97, v97
    v_exp_f32 v98, v98
    v_smfmac_f32_32x32x32_bf16 v[176:191], v[124:127], v[88:95], v152
    v_exp_f32 v99, v99
    v_exp_f32 v100, v100
    v_exp_f32 v101, v101
    v_exp_f32 v102, v102
    s_setprio 0
    v_exp_f32 v103, v103
    ds_read_b128 v[24:27], v154 offset:16384
    s_mov_b64 exec, s[56:57]
    ds_read_b128 v[128:131], v153 offset:29952
    ds_read_b128 v[124:127], v153 offset:31744
    s_mov_b64 exec, -1
    s_add_u32 m0, s18, 65536
    s_add_u32 s58, s23, 0
    buffer_load_dwordx4 v244, s[44:47], s58 offen lds
CD_P61:
    s_waitcnt lgkmcnt(3)
    v_exp_f32 v64, v64
    s_setprio 1
    v_exp_f32 v65, v65
    v_max3_f32 v104, v196, v197, v198
    v_exp_f32 v66, v66
    v_max3_f32 v105, v199, v200, v201
    v_exp_f32 v67, v67
    v_smfmac_f32_32x32x32_bf16 v[176:191], v[132:135], v[96:103], v152
    v_max3_f32 v104, v104, v202, v203
    v_exp_f32 v68, v68
    v_max3_f32 v105, v105, v204, v205
    v_exp_f32 v69, v69
    v_max3_f32 v104, v104, v206, v207
    v_exp_f32 v70, v70
    v_max3_f32 v105, v105, v208, v209
    v_exp_f32 v71, v71
    v_mfma_f32_32x32x16_bf16 v[88:103], v[28:31], v[8:11], v[48:63]
    v_max3_f32 v104, v104, v210, v211
    v_exp_f32 v72, v72
    v_max_f32 v104, v104, v105
    v_exp_f32 v73, v73
    v_mov_b32 v105, v104
    v_exp_f32 v74, v74
    v_exp_f32 v75, v75
    v_smfmac_f32_32x32x32_bf16 v[176:191], v[120:123], v[64:71], v152
    v_permlane32_swap_b32 v104, v105
    v_exp_f32 v76, v76
    v_exp_f32 v77, v77
    v_min_f32 v32, -v104, -v105
    v_min_f32 v33, -v104, -v105
    v_exp_f32 v78, v78
    s_setprio 0
    v_exp_f32 v79, v79
    ds_read_b128 v[28:31], v154 offset:14336
    s_mov_b64 exec, s[56:57]
    ds_read_b128 v[132:135], v153 offset:32000
    ds_read_b128 v[120:123], v154 offset:17408
    s_mov_b64 exec, -1
    s_add_u32 m0, s18, 73728
    s_add_u32 s58, s23, 65536
    buffer_load_dwordx4 v244, s[44:47], s58 offen lds
CD_P62:
    s_waitcnt lgkmcnt(3)
    v_exp_f32 v88, v88
    s_setprio 1
    v_exp_f32 v89, v89
    v_pk_add_f32 v[136:137], v[136:137], v[32:33]
    v_pk_add_f32 v[138:139], v[138:139], v[32:33]
    v_exp_f32 v90, v90
    v_pk_add_f32 v[140:141], v[140:141], v[32:33]
    v_pk_add_f32 v[142:143], v[142:143], v[32:33]
    v_exp_f32 v91, v91
    v_smfmac_f32_32x32x32_bf16 v[176:191], v[128:131], v[72:79], v152
    v_pk_add_f32 v[144:145], v[144:145], v[32:33]
    v_pk_add_f32 v[146:147], v[146:147], v[32:33]
    v_exp_f32 v92, v92
    v_pk_add_f32 v[148:149], v[148:149], v[32:33]
    v_pk_add_f32 v[150:151], v[150:151], v[32:33]
    v_exp_f32 v93, v93
    v_exp_f32 v94, v94
    v_exp_f32 v95, v95
    v_mfma_f32_32x32x16_bf16 v[64:79], v[24:27], v[4:7], v[136:151]
    v_exp_f32 v96, v96
    v_mov_b64 v[34:35], v[32:33]
    v_exp_f32 v97, v97
    v_mov_b64 v[36:37], v[32:33]
    v_exp_f32 v98, v98
    v_mov_b64 v[38:39], v[32:33]
    v_exp_f32 v99, v99
    v_smfmac_f32_32x32x32_bf16 v[176:191], v[124:127], v[88:95], v152
    v_mov_b64 v[40:41], v[32:33]
    v_exp_f32 v100, v100
    v_mov_b64 v[42:43], v[32:33]
    v_exp_f32 v101, v101
    v_mov_b64 v[44:45], v[32:33]
    v_exp_f32 v102, v102
    v_mov_b64 v[46:47], v[32:33]
    v_add_u32 v3, 4, v110
    s_setprio 0
    v_exp_f32 v103, v103
    s_cmp_eq_u32 s10, 0
    s_cbranch_scc1 Lcf_44
Lcb_45:
    ds_read_b128 v[24:27], v154 offset:12288
    ds_write_b32 v109, v3
    s_mov_b64 exec, s[56:57]
    ds_read_b128 v[128:131], v154 offset:17664
    ds_read_b128 v[124:127], v154 offset:15360
    s_mov_b64 exec, -1
    s_add_u32 m0, s18, 81920
    s_add_u32 s58, s23, 131072
    buffer_load_dwordx4 v244, s[44:47], s58 offen lds
CD_P63:
    s_waitcnt lgkmcnt(4)
    v_exp_f32 v64, v64
    s_setprio 1
    v_exp_f32 v65, v65
    v_exp_f32 v66, v66
    v_exp_f32 v67, v67
    v_smfmac_f32_32x32x32_bf16 v[176:191], v[132:135], v[96:103], v152
    v_exp_f32 v68, v68
    v_exp_f32 v69, v69
    v_exp_f32 v70, v70
    v_exp_f32 v71, v71
    v_mfma_f32_32x32x16_bf16 v[88:103], v[28:31], v[4:7], v[32:47]
    v_exp_f32 v72, v72
    v_exp_f32 v73, v73
    v_exp_f32 v74, v74
    v_exp_f32 v75, v75
    v_smfmac_f32_32x32x32_bf16 v[160:175], v[120:123], v[64:71], v152
    v_exp_f32 v76, v76
    v_exp_f32 v77, v77
    v_exp_f32 v78, v78
    s_setprio 0
    v_exp_f32 v79, v79
    s_cmp_eq_u32 s10, 1
    s_cbranch_scc1 Lcf_46
Lcb_47:
    ds_read_b128 v[28:31], v154 offset:10240
    ds_read_b32 v108, v247
    s_mov_b64 exec, s[56:57]
    ds_read_b128 v[132:135], v154 offset:15616
    ds_read_b128 v[120:123], v154 offset:13312
    s_mov_b64 exec, -1
    s_add_u32 m0, s18, 90112
    s_add_u32 s58, s23, 196608
    buffer_load_dwordx4 v244, s[44:47], s58 offen lds
CD_P64:
    s_waitcnt lgkmcnt(4)
    v_exp_f32 v88, v88
    s_setprio 1
    v_exp_f32 v89, v89
    v_rcp_f32 v106, v184
    v_sub_f32 v107, 1.0, v155
    v_exp_f32 v90, v90
    v_add_f32 v104, abs(v176), abs(v177)
    v_exp_f32 v91, v91
    v_smfmac_f32_32x32x32_bf16 v[160:175], v[128:131], v[72:79], v152
    v_add_f32 v105, abs(v178), abs(v179)
    v_add_f32 v104, v104, abs(v180)
    v_exp_f32 v92, v92
    v_add_f32 v105, v105, abs(v181)
    v_exp_f32 v93, v93
    v_add_f32 v104, v104, abs(v182)
    v_add_f32 v105, v105, abs(v183)
    v_exp_f32 v94, v94
    v_fmac_f32 v104, 0x6b000000, v184
    v_exp_f32 v95, v95
    v_mfma_f32_32x32x16_bf16 v[64:79], v[24:27], v[4:7], v[32:47]
    v_add_f32 v104, v104, v105
    v_exp_f32 v96, v96
    v_cmp_ngt_f32 vcc, 0x7f000000, v104
    v_mul_f32 v106, v106, v107
    v_exp_f32 v97, v97
    v_pk_mul_f32 v[176:177], v[176:177], v[106:107] op_sel_hi:[1,0]
    v_exp_f32 v98, v98
    v_pk_mul_f32 v[178:179], v[178:179], v[106:107] op_sel_hi:[1,0]
    v_pk_mul_f32 v[180:181], v[180:181], v[106:107] op_sel_hi:[1,0]
    v_exp_f32 v99, v99
    v_smfmac_f32_32x32x32_bf16 v[160:175], v[124:127], v[88:95], v152
    v_pk_mul_f32 v[182:183], v[182:183], v[106:107] op_sel_hi:[1,0]
    v_exp_f32 v100, v100
    v_cvt_pk_bf16_f32 v188, v176, v177
    v_cvt_pk_bf16_f32 v189, v178, v179
    v_exp_f32 v101, v101
    v_cvt_pk_bf16_f32 v190, v180, v181
    v_exp_f32 v102, v102
    v_cvt_pk_bf16_f32 v191, v182, v183
    s_setprio 0
    v_exp_f32 v103, v103
    s_cmp_eq_u32 s10, 2
    s_cbranch_scc1 Lcf_48
Lcb_49:
    s_cbranch_vccnz Lfbk_50
Lfok_51:
    buffer_store_dwordx4 v[188:191], v2, s[32:35], s15 offen sc1
    ds_read_b128 v[24:27], v154 offset:8192
    s_mov_b64 exec, s[56:57]
    ds_read_b128 v[128:131], v154 offset:13568
    ds_read_b128 v[124:127], v154 offset:11264
    s_mov_b64 exec, -1
    s_add_u32 m0, s18, 98304
    s_add_u32 s58, s23, 262144
    buffer_load_dwordx4 v244, s[44:47], s58 offen lds
CD_P65:
    s_waitcnt lgkmcnt(3)
    v_exp_f32 v64, v64
    s_setprio 1
    v_exp_f32 v65, v65
    v_exp_f32 v66, v66
    v_exp_f32 v67, v67
    v_smfmac_f32_32x32x32_bf16 v[160:175], v[132:135], v[96:103], v152
    v_exp_f32 v68, v68
    v_exp_f32 v69, v69
    v_exp_f32 v70, v70
    v_exp_f32 v71, v71
    v_mfma_f32_32x32x16_bf16 v[88:103], v[28:31], v[4:7], v[32:47]
    v_exp_f32 v72, v72
    v_exp_f32 v73, v73
    v_exp_f32 v74, v74
    v_exp_f32 v75, v75
    v_smfmac_f32_32x32x32_bf16 v[160:175], v[120:123], v[64:71], v152
    v_exp_f32 v76, v76
    v_sub_u32 v108, v3, v108
    v_exp_f32 v77, v77
    v_exp_f32 v78, v78
    v_cmp_eq_u32 vcc, 1, v108
    s_setprio 0
    v_exp_f32 v79, v79
    s_cmp_eq_u32 s10, 3
    s_cbranch_scc1 Lcf_52
Lcb_53:
    s_cbranch_vccnz Lsy_42
Lsyd_43:
    ds_read_b128 v[28:31], v154 offset:6144
    s_mov_b64 exec, s[56:57]
    ds_read_b128 v[132:135], v154 offset:11520
    ds_read_b128 v[120:123], v154 offset:9216
    s_mov_b64 exec, -1
    s_add_u32 m0, s18, 106496
    s_add_u32 s58, s23, 327680
    buffer_load_dwordx4 v244, s[44:47], s58 offen lds
    s_add_u32 m0, s18, 114688
    s_add_u32 s58, s23, 393216
    buffer_load_dwordx4 v244, s[44:47], s58 offen lds
CD_P66:
    s_waitcnt lgkmcnt(3)
    v_exp_f32 v88, v88
    s_setprio 1
    v_exp_f32 v89, v89
    v_exp_f32 v90, v90
    v_exp_f32 v91, v91
    v_smfmac_f32_32x32x32_bf16 v[160:175], v[128:131], v[72:79], v152
    v_exp_f32 v92, v92
    v_exp_f32 v93, v93
    v_exp_f32 v94, v94
    v_exp_f32 v95, v95
    v_mfma_f32_32x32x16_bf16 v[64:79], v[24:27], v[4:7], v[32:47]
    v_exp_f32 v96, v96
    v_exp_f32 v97, v97
    v_exp_f32 v98, v98
    v_exp_f32 v99, v99
    v_smfmac_f32_32x32x32_bf16 v[160:175], v[124:127], v[88:95], v152
    v_exp_f32 v100, v100
    v_exp_f32 v101, v101
    v_exp_f32 v102, v102
    s_setprio 0
    v_exp_f32 v103, v103
    s_cmp_eq_u32 s10, 4
    s_cbranch_scc1 Lcf_54
Lcb_55:
    ds_read_b128 v[24:27], v154 offset:4096
    s_mov_b64 exec, s[56:57]
    ds_read_b128 v[128:131], v154 offset:9472
    ds_read_b128 v[124:127], v154 offset:7168
    s_mov_b64 exec, -1
    s_add_u32 m0, s18, 122880
    s_add_u32 s58, s23, 458752
    buffer_load_dwordx4 v244, s[44:47], s58 offen lds
CD_P67:
    s_waitcnt lgkmcnt(3)
    v_exp_f32 v64, v64
    s_setprio 1
    v_exp_f32 v65, v65
    v_exp_f32 v66, v66
    v_exp_f32 v67, v67
    v_smfmac_f32_32x32x32_bf16 v[160:175], v[132:135], v[96:103], v152
    v_exp_f32 v68, v68
    v_exp_f32 v69, v69
    v_exp_f32 v70, v70
    v_exp_f32 v71, v71
    v_mfma_f32_32x32x16_bf16 v[88:103], v[28:31], v[4:7], v[32:47]
    v_exp_f32 v72, v72
    v_exp_f32 v73, v73
    v_exp_f32 v74, v74
    v_exp_f32 v75, v75
    v_smfmac_f32_32x32x32_bf16 v[160:175], v[120:123], v[64:71], v152
    v_exp_f32 v76, v76
    v_exp_f32 v77, v77
    v_exp_f32 v78, v78
    s_setprio 0
    v_exp_f32 v79, v79
    s_cmp_eq_u32 s10, 5
    s_cbranch_scc1 Lcf_56
Lcb_57:
    ds_read_b128 v[28:31], v154 offset:2048
    s_mov_b64 exec, s[56:57]
    ds_read_b128 v[132:135], v154 offset:7424
    ds_read_b128 v[120:123], v154 offset:5120
    s_mov_b64 exec, -1
    buffer_load_dwordx4 v[192:195], v2, s[32:35], s51 offen offset:0 sc1
    buffer_load_dwordx4 v[196:199], v2, s[32:35], s51 offen offset:1024 sc1
CD_P68:
    s_waitcnt lgkmcnt(3)
    v_exp_f32 v88, v88
    s_setprio 1
    v_exp_f32 v89, v89
    v_exp_f32 v90, v90
    v_exp_f32 v91, v91
    v_smfmac_f32_32x32x32_bf16 v[160:175], v[128:131], v[72:79], v152
    v_exp_f32 v92, v92
    v_exp_f32 v93, v93
    v_exp_f32 v94, v94
    v_exp_f32 v95, v95
    v_mfma_f32_32x32x16_bf16 v[64:79], v[24:27], v[4:7], v[32:47]
    v_exp_f32 v96, v96
    v_exp_f32 v97, v97
    v_exp_f32 v98, v98
    v_exp_f32 v99, v99
    v_smfmac_f32_32x32x32_bf16 v[160:175], v[124:127], v[88:95], v152
    v_exp_f32 v100, v100
    v_exp_f32 v101, v101
    v_exp_f32 v102, v102
    s_setprio 0
    v_exp_f32 v103, v103
    s_cmp_eq_u32 s10, 6
    s_cbranch_scc1 Lcf_58
Lcb_59:
    ds_read_b128 v[24:27], v154 offset:0
    s_mov_b64 exec, s[56:57]
    ds_read_b128 v[128:131], v154 offset:5376
    ds_read_b128 v[124:127], v154 offset:3072
    s_mov_b64 exec, -1
    buffer_load_dwordx4 v[200:203], v2, s[32:35], s51 offen offset:2048 sc1
    buffer_load_dwordx4 v[204:207], v2, s[32:35], s51 offen offset:3072 sc1
CD_P69:
    s_waitcnt lgkmcnt(3)
    v_exp_f32 v64, v64
    s_setprio 1
    v_exp_f32 v65, v65
    v_cndmask_b32 v136, v32, v157, s[64:65]
    v_cndmask_b32 v137, v33, v157, s[66:67]
    v_exp_f32 v66, v66
    v_cndmask_b32 v138, v34, v157, s[68:69]
    v_exp_f32 v67, v67
    v_smfmac_f32_32x32x32_bf16 v[160:175], v[132:135], v[96:103], v152
    v_cndmask_b32 v139, v35, v157, s[70:71]
    v_exp_f32 v68, v68
    v_cndmask_b32 v140, v36, v157, s[72:73]
    v_exp_f32 v69, v69
    v_cndmask_b32 v141, v37, v157, s[74:75]
    v_exp_f32 v70, v70
    v_cndmask_b32 v142, v38, v157, s[76:77]
    v_exp_f32 v71, v71
    v_mfma_f32_32x32x16_bf16 v[88:103], v[28:31], v[4:7], v[32:47]
    v_cndmask_b32 v143, v39, v157, s[78:79]
    v_exp_f32 v72, v72
    v_cndmask_b32 v144, v40, v157, s[80:81]
    v_cndmask_b32 v145, v41, v157, s[82:83]
    v_exp_f32 v73, v73
    v_cndmask_b32 v146, v42, v157, s[84:85]
    v_exp_f32 v74, v74
    v_cndmask_b32 v147, v43, v157, s[86:87]
    v_exp_f32 v75, v75
    v_smfmac_f32_32x32x32_bf16 v[160:175], v[120:123], v[64:71], v152
    v_cndmask_b32 v148, v44, v157, s[88:89]
    v_exp_f32 v76, v76
    v_cndmask_b32 v149, v45, v157, s[90:91]
    v_exp_f32 v77, v77
    v_cndmask_b32 v150, v46, v157, s[92:93]
    v_exp_f32 v78, v78
    v_cndmask_b32 v151, v47, v157, s[94:95]
    s_setprio 0
    v_exp_f32 v79, v79
    s_cmp_eq_u32 s9, 0
    s_cbranch_scc1 Lff_60
Lfk_61:
    s_mov_b64 exec, s[56:57]
    ds_read_b128 v[132:135], v154 offset:3328
    ds_read_b128 v[120:123], v154 offset:1024
    s_mov_b64 exec, -1
    buffer_load_dwordx4 v[208:211], v2, s[32:35], s52 offen offset:0 sc1
    buffer_load_dwordx4 v[212:215], v2, s[32:35], s52 offen offset:1024 sc1
CD_P70:
    s_waitcnt lgkmcnt(2)
    v_exp_f32 v88, v88
    s_setprio 1
    v_exp_f32 v89, v89
    v_exp_f32 v90, v90
    v_exp_f32 v91, v91
    v_smfmac_f32_32x32x32_bf16 v[160:175], v[128:131], v[72:79], v152
    v_exp_f32 v92, v92
    v_exp_f32 v93, v93
    v_exp_f32 v94, v94
    v_exp_f32 v95, v95
    v_mfma_f32_32x32x16_bf16 v[64:79], v[24:27], v[4:7], v[136:151]
    v_exp_f32 v96, v96
    v_exp_f32 v97, v97
    v_exp_f32 v98, v98
    v_exp_f32 v99, v99
    v_smfmac_f32_32x32x32_bf16 v[160:175], v[124:127], v[88:95], v152
    v_exp_f32 v100, v100
    v_exp_f32 v101, v101
    v_exp_f32 v102, v102
    s_setprio 0
    v_exp_f32 v103, v103
    s_mov_b64 exec, s[56:57]
    ds_read_b128 v[128:131], v154 offset:1280
    s_mov_b64 exec, -1
    buffer_load_dwordx4 v[216:219], v2, s[32:35], s52 offen offset:2048 sc1
    buffer_load_dwordx4 v[220:223], v2, s[32:35], s52 offen offset:3072 sc1
CD_P71:
    s_waitcnt lgkmcnt(1)
    v_exp_f32 v64, v64
    s_setprio 1
    v_exp_f32 v65, v65
    v_exp_f32 v66, v66
    v_exp_f32 v67, v67
    v_smfmac_f32_32x32x32_bf16 v[160:175], v[132:135], v[96:103], v152
    v_exp_f32 v68, v68
    v_exp_f32 v69, v69
    v_exp_f32 v70, v70
    v_exp_f32 v71, v71
    v_exp_f32 v72, v72
    v_exp_f32 v73, v73
    v_exp_f32 v74, v74
    v_exp_f32 v75, v75
    v_smfmac_f32_32x32x32_bf16 v[160:175], v[120:123], v[64:71], v152
    v_exp_f32 v76, v76
    v_exp_f32 v77, v77
    v_exp_f32 v78, v78
    s_setprio 0
    v_exp_f32 v79, v79
    s_waitcnt lgkmcnt(0)
    s_nop 0
    v_smfmac_f32_32x32x32_bf16 v[160:175], v[128:131], v[72:79], v152
    s_nop 7
    s_nop 3
    v_rcp_f32 v106, v168
    v_mov_b32 v107, v155
    v_add_f32 v104, abs(v160), abs(v161)
    v_add_f32 v105, abs(v162), abs(v163)
    v_add_f32 v104, v104, abs(v164)
    v_add_f32 v105, v105, abs(v165)
    v_add_f32 v104, v104, abs(v166)
    v_add_f32 v105, v105, abs(v167)
    v_fmac_f32 v104, 0x6b000000, v168
    v_add_f32 v104, v104, v105
    v_cmp_ngt_f32 vcc, 0x7f000000, v104
    v_mul_f32 v106, v106, v107
    v_pk_mul_f32 v[160:161], v[160:161], v[106:107] op_sel_hi:[1,0]
    v_pk_mul_f32 v[162:163], v[162:163], v[106:107] op_sel_hi:[1,0]
    v_pk_mul_f32 v[164:165], v[164:165], v[106:107] op_sel_hi:[1,0]
    v_pk_mul_f32 v[166:167], v[166:167], v[106:107] op_sel_hi:[1,0]
    v_cvt_pk_bf16_f32 v172, v160, v161
    v_cvt_pk_bf16_f32 v173, v162, v163
    v_cvt_pk_bf16_f32 v174, v164, v165
    v_cvt_pk_bf16_f32 v175, v166, v167
    s_cbranch_vccnz Lfbk_62
Lfok_63:
    buffer_store_dwordx4 v[172:175], v2, s[32:35], s14 offen sc1
CD_Pe0:
    s_branch SK_Pe0
.p2align 12
PG_Pe0:
    s_setpc_b64 s[100:101]
SK_Pe0:
    s_waitcnt vmcnt(9)
    s_barrier
    v_add_u32 v3, 5, v110
    v_mov_b32 v11, v109
    ds_read_b64_tr_b16 v[56:57], v18 offset:0
    ds_read_b64_tr_b16 v[58:59], v18 offset:1024
    ds_read_b64_tr_b16 v[60:61], v19 offset:0
    ds_read_b64_tr_b16 v[62:63], v19 offset:1024
    ds_read_b64_tr_b16 v[64:65], v18 offset:2048
    ds_read_b64_tr_b16 v[66:67], v18 offset:3072
    ds_read_b64_tr_b16 v[68:69], v19 offset:2048
    ds_read_b64_tr_b16 v[70:71], v19 offset:3072
    ds_read_b64_tr_b16 v[72:73], v18 offset:4096
    ds_read_b64_tr_b16 v[74:75], v18 offset:5120
    ds_read_b64_tr_b16 v[76:77], v19 offset:4096
    ds_read_b64_tr_b16 v[78:79], v19 offset:5120
    s_waitcnt vmcnt(1)
    v_max3_u32 v10, v192, v193, v194
    v_max3_u32 v9, v195, v196, v197
    v_max3_u32 v10, v10, v198, v199
    v_max3_u32 v9, v9, v200, v201
    v_max3_u32 v10, v10, v202, v203
    v_max3_u32 v9, v9, v204, v205
    v_max3_u32 v10, v10, v206, v207
    v_max3_u32 v9, v9, v208, v209
    v_max3_u32 v10, v10, v210, v211
    v_max3_u32 v9, v9, v212, v213
    v_max3_u32 v10, v10, v214, v215
    v_max3_u32 v9, v9, v216, v217
    v_max3_u32 v10, v10, v218, v219
    v_max3_u32 v9, v9, v220, v221
    v_max3_u32 v10, v10, v222, v223
    v_max_u32 v10, v10, v9
    v_cmp_eq_u32 vcc, -1, v10
    s_cbranch_vccnz L_OB
L_OBD:
    s_waitcnt lgkmcnt(8)
    v_mfma_f32_32x32x16_bf16 v[24:39], v[56:59], v[192:195], 0
    ds_read_b64_tr_b16 v[80:81], v18 offset:6144
    ds_read_b64_tr_b16 v[82:83], v18 offset:7168
    v_mfma_f32_32x32x16_bf16 v[40:55], v[60:63], v[192:195], 0
    ds_read_b64_tr_b16 v[84:85], v19 offset:6144
    ds_read_b64_tr_b16 v[86:87], v19 offset:7168
    s_waitcnt lgkmcnt(8)
    v_mfma_f32_32x32x16_bf16 v[24:39], v[64:67], v[196:199], v[24:39]
    ds_read_b64_tr_b16 v[88:89], v18 offset:8192
    ds_read_b64_tr_b16 v[90:91], v18 offset:9216
    v_mfma_f32_32x32x16_bf16 v[40:55], v[68:71], v[196:199], v[40:55]
    ds_read_b64_tr_b16 v[92:93], v19 offset:8192
    ds_read_b64_tr_b16 v[94:95], v19 offset:9216
    s_waitcnt lgkmcnt(8)
    v_mfma_f32_32x32x16_bf16 v[24:39], v[72:75], v[200:203], v[24:39]
    ds_read_b64_tr_b16 v[96:97], v18 offset:10240
    ds_read_b64_tr_b16 v[98:99], v18 offset:11264
    v_mfma_f32_32x32x16_bf16 v[40:55], v[76:79], v[200:203], v[40:55]
    ds_read_b64_tr_b16 v[100:101], v19 offset:10240
    ds_read_b64_tr_b16 v[102:103], v19 offset:11264
    s_waitcnt lgkmcnt(8)
    v_mfma_f32_32x32x16_bf16 v[24:39], v[80:83], v[204:207], v[24:39]
    ds_read_b64_tr_b16 v[104:105], v18 offset:12288
    ds_read_b64_tr_b16 v[106:107], v18 offset:13312
    ds_read_b64_tr_b16 v[108:109], v19 offset:12288
    v_mfma_f32_32x32x16_bf16 v[40:55], v[84:87], v[204:207], v[40:55]
    ds_read_b64_tr_b16 v[110:111], v19 offset:13312
    ds_read_b64_tr_b16 v[112:113], v18 offset:14336
    ds_read_b64_tr_b16 v[114:115], v18 offset:15360
    s_waitcnt lgkmcnt(9)
    v_mfma_f32_32x32x16_bf16 v[24:39], v[88:91], v[208:211], v[24:39]
    ds_read_b64_tr_b16 v[116:117], v19 offset:14336
    ds_read_b64_tr_b16 v[118:119], v19 offset:15360
    ds_read_b64_tr_b16 v[56:57], v16 offset:0
    v_mfma_f32_32x32x16_bf16 v[40:55], v[92:95], v[208:211], v[40:55]
    ds_read_b64_tr_b16 v[58:59], v16 offset:1024
    ds_read_b64_tr_b16 v[60:61], v17 offset:0
    ds_read_b64_tr_b16 v[62:63], v17 offset:1024
    s_waitcnt lgkmcnt(9)
    v_mfma_f32_32x32x16_bf16 v[24:39], v[96:99], v[212:215], v[24:39]
    ds_read_b64_tr_b16 v[64:65], v16 offset:2048
    ds_read_b64_tr_b16 v[66:67], v16 offset:3072
    ds_read_b64_tr_b16 v[68:69], v17 offset:2048
    v_mfma_f32_32x32x16_bf16 v[40:55], v[100:103], v[212:215], v[40:55]
    ds_read_b64_tr_b16 v[70:71], v17 offset:3072
    ds_read_b64_tr_b16 v[72:73], v16 offset:4096
    ds_read_b64_tr_b16 v[74:75], v16 offset:5120
    s_waitcnt lgkmcnt(9)
    v_mfma_f32_32x32x16_bf16 v[24:39], v[104:107], v[216:219], v[24:39]
    ds_read_b64_tr_b16 v[76:77], v17 offset:4096
    ds_read_b64_tr_b16 v[78:79], v17 offset:5120
    ds_read_b64_tr_b16 v[80:81], v16 offset:6144
    v_mfma_f32_32x32x16_bf16 v[40:55], v[108:111], v[216:219], v[40:55]
    ds_read_b64_tr_b16 v[82:83], v16 offset:7168
    ds_read_b64_tr_b16 v[84:85], v17 offset:6144
    ds_read_b64_tr_b16 v[86:87], v17 offset:7168
    buffer_load_dwordx4 v[120:123], v2, s[32:35], s54 offen offset:0 sc1
    buffer_load_dwordx4 v[124:127], v2, s[32:35], s54 offen offset:1024 sc1
    buffer_load_dwordx4 v[128:131], v2, s[32:35], s54 offen offset:2048 sc1
    buffer_load_dwordx4 v[132:135], v2, s[32:35], s54 offen offset:3072 sc1
    buffer_load_dwordx4 v[136:139], v2, s[32:35], s55 offen offset:0 sc1
    buffer_load_dwordx4 v[140:143], v2, s[32:35], s55 offen offset:1024 sc1
    buffer_load_dwordx4 v[144:147], v2, s[32:35], s55 offen offset:2048 sc1
    buffer_load_dwordx4 v[148:151], v2, s[32:35], s55 offen offset:3072 sc1
    s_waitcnt lgkmcnt(9)
    v_mfma_f32_32x32x16_bf16 v[24:39], v[112:115], v[220:223], v[24:39]
    ds_read_b64_tr_b16 v[88:89], v16 offset:8192
    ds_read_b64_tr_b16 v[90:91], v16 offset:9216
    ds_read_b64_tr_b16 v[92:93], v17 offset:8192
    v_mfma_f32_32x32x16_bf16 v[40:55], v[116:119], v[220:223], v[40:55]
    ds_read_b64_tr_b16 v[94:95], v17 offset:9216
    ds_read_b64_tr_b16 v[96:97], v16 offset:10240
    ds_read_b64_tr_b16 v[98:99], v16 offset:11264
    s_waitcnt lgkmcnt(9)
    ds_read_b64_tr_b16 v[100:101], v17 offset:10240
    ds_read_b64_tr_b16 v[102:103], v17 offset:11264
    ds_read_b64_tr_b16 v[104:105], v16 offset:12288
    ds_read_b64_tr_b16 v[106:107], v16 offset:13312
    ds_read_b64_tr_b16 v[108:109], v17 offset:12288
    s_waitcnt lgkmcnt(9)
    ds_read_b64_tr_b16 v[110:111], v17 offset:13312
    ds_read_b64_tr_b16 v[112:113], v16 offset:14336
    ds_read_b64_tr_b16 v[114:115], v16 offset:15360
    ds_read_b64_tr_b16 v[116:117], v17 offset:14336
    ds_read_b64_tr_b16 v[118:119], v17 offset:15360
CD_Pe1:
    ds_write_b32 v11, v3
    s_mov_b32 s62, 20000
    s_waitcnt lgkmcnt(0)
CD_Pe2:
L_OA:
    s_waitcnt vmcnt(7)
    v_mfma_f32_32x32x16_bf16 v[152:167], v[56:59], v[120:123], v[24:39]
    v_max_u32 v10, v120, v121
    v_mfma_f32_32x32x16_bf16 v[168:183], v[60:63], v[120:123], v[40:55]
    v_max3_u32 v10, v10, v122, v123
    s_waitcnt vmcnt(6)
    v_mfma_f32_32x32x16_bf16 v[152:167], v[64:67], v[124:127], v[152:167]
    v_max3_u32 v10, v10, v124, v125
    v_mfma_f32_32x32x16_bf16 v[168:183], v[68:71], v[124:127], v[168:183]
    v_max3_u32 v10, v10, v126, v127
    s_waitcnt vmcnt(5)
    v_mfma_f32_32x32x16_bf16 v[152:167], v[72:75], v[128:131], v[152:167]
    v_max3_u32 v10, v10, v128, v129
    v_mfma_f32_32x32x16_bf16 v[168:183], v[76:79], v[128:131], v[168:183]
    v_max3_u32 v10, v10, v130, v131
    s_waitcnt vmcnt(4)
    v_mfma_f32_32x32x16_bf16 v[152:167], v[80:83], v[132:135], v[152:167]
    v_max3_u32 v10, v10, v132, v133
    v_mfma_f32_32x32x16_bf16 v[168:183], v[84:87], v[132:135], v[168:183]
    v_max3_u32 v10, v10, v134, v135
    s_waitcnt vmcnt(3)
    v_mfma_f32_32x32x16_bf16 v[152:167], v[88:91], v[136:139], v[152:167]
    v_max3_u32 v10, v10, v136, v137
    v_mfma_f32_32x32x16_bf16 v[168:183], v[92:95], v[136:139], v[168:183]
    v_max3_u32 v10, v10, v138, v139
    s_waitcnt vmcnt(2)
    v_mfma_f32_32x32x16_bf16 v[152:167], v[96:99], v[140:143], v[152:167]
    v_max3_u32 v10, v10, v140, v141
    v_mfma_f32_32x32x16_bf16 v[168:183], v[100:103], v[140:143], v[168:183]
    v_max3_u32 v10, v10, v142, v143
    s_waitcnt vmcnt(1)
    v_mfma_f32_32x32x16_bf16 v[152:167], v[104:107], v[144:147], v[152:167]
    v_max3_u32 v10, v10, v144, v145
    v_mfma_f32_32x32x16_bf16 v[168:183], v[108:111], v[144:147], v[168:183]
    v_max3_u32 v10, v10, v146, v147
    ds_read_b32 v9, v247
    s_waitcnt vmcnt(0)
    v_mfma_f32_32x32x16_bf16 v[152:167], v[112:115], v[148:151], v[152:167]
    v_max3_u32 v10, v10, v148, v149
    v_mfma_f32_32x32x16_bf16 v[168:183], v[116:119], v[148:151], v[168:183]
    v_max3_u32 v10, v10, v150, v151
    v_cmp_eq_u32 vcc, -1, v10
    s_sub_u32 s62, s62, 1
    s_cbranch_vccz L_OAD
    s_cbranch_scc1 L_OAD
    buffer_load_dwordx4 v[120:123], v2, s[32:35], s54 offen offset:0 sc1
    buffer_load_dwordx4 v[124:127], v2, s[32:35], s54 offen offset:1024 sc1
    buffer_load_dwordx4 v[128:131], v2, s[32:35], s54 offen offset:2048 sc1
    buffer_load_dwordx4 v[132:135], v2, s[32:35], s54 offen offset:3072 sc1
    buffer_load_dwordx4 v[136:139], v2, s[32:35], s55 offen offset:0 sc1
    buffer_load_dwordx4 v[140:143], v2, s[32:35], s55 offen offset:1024 sc1
    buffer_load_dwordx4 v[144:147], v2, s[32:35], s55 offen offset:2048 sc1
    buffer_load_dwordx4 v[148:151], v2, s[32:35], s55 offen offset:3072 sc1
    s_branch L_OA
L_OAD:
CD_Pe3:
    s_waitcnt lgkmcnt(0)
    v_cmp_ne_u32 vcc, v9, v3
    s_cbranch_vccnz L_SY5
L_SY5D:
    v_xor_b32 v25, 32, v20
    v_xor_b32 v26, 64, v20
    v_xor_b32 v27, 96, v20
    v_xor_b32 v28, 128, v20
    v_xor_b32 v29, 160, v20
    v_xor_b32 v30, 192, v20
    v_xor_b32 v31, 224, v20
    ds_write_b128 v20, v[152:155]
    ds_write_b128 v25, v[156:159]
    ds_write_b128 v26, v[160:163]
    ds_write_b128 v27, v[164:167]
    ds_write_b128 v28, v[168:171]
    ds_write_b128 v29, v[172:175]
    ds_write_b128 v30, v[176:179]
    ds_write_b128 v31, v[180:183]
    s_waitcnt lgkmcnt(0)
    s_barrier
    ds_read_b128 v[56:59], v22 offset:0
    ds_read_b128 v[60:63], v23 offset:0
    ds_read_b128 v[64:67], v22 offset:16384
    ds_read_b128 v[68:71], v23 offset:16384
    ds_read_b128 v[72:75], v22 offset:32768
    ds_read_b128 v[76:79], v23 offset:32768
    ds_read_b128 v[80:83], v22 offset:49152
    ds_read_b128 v[84:87], v23 offset:49152
    s_waitcnt lgkmcnt(4)
    v_pk_add_f32 v[56:57], v[56:57], v[64:65]
    v_pk_add_f32 v[58:59], v[58:59], v[66:67]
    v_pk_add_f32 v[60:61], v[60:61], v[68:69]
    v_pk_add_f32 v[62:63], v[62:63], v[70:71]
    s_waitcnt lgkmcnt(2)
    v_pk_add_f32 v[56:57], v[56:57], v[72:73]
    v_pk_add_f32 v[58:59], v[58:59], v[74:75]
    v_pk_add_f32 v[60:61], v[60:61], v[76:77]
    v_pk_add_f32 v[62:63], v[62:63], v[78:79]
    s_waitcnt lgkmcnt(0)
    v_pk_add_f32 v[56:57], v[56:57], v[80:81]
    v_pk_add_f32 v[58:59], v[58:59], v[82:83]
    v_pk_add_f32 v[60:61], v[60:61], v[84:85]
    v_pk_add_f32 v[62:63], v[62:63], v[86:87]
    v_cvt_pk_bf16_f32 v12, v56, v57
    v_cvt_pk_bf16_f32 v13, v58, v59
    v_cvt_pk_bf16_f32 v14, v60, v61
    v_cvt_pk_bf16_f32 v15, v62, v63
    buffer_store_dwordx4 v[12:15], v243, s[36:39], s63 offen nt
L_END:
    s_endpgm
CD_zz:
.p2align 6
PG_K:
    s_setpc_b64 s[100:101]
L_SY5:
    s_mov_b32 s62, 320000
L_SY5R:
    s_sleep 1
    ds_read_b32 v9, v247
    s_waitcnt lgkmcnt(0)
    v_cmp_ne_u32 vcc, v9, v3
    s_sub_u32 s62, s62, 1
    s_cbranch_scc1 L_SY5D
    s_cbranch_vccnz L_SY5R
    s_branch L_SY5D
L_OB:
    s_mov_b32 s62, 20000
L_OB2:
    buffer_load_dwordx4 v[192:195], v2, s[32:35], s51 offen offset:0 sc1
    buffer_load_dwordx4 v[196:199], v2, s[32:35], s51 offen offset:1024 sc1
    buffer_load_dwordx4 v[200:203], v2, s[32:35], s51 offen offset:2048 sc1
    buffer_load_dwordx4 v[204:207], v2, s[32:35], s51 offen offset:3072 sc1
    buffer_load_dwordx4 v[208:211], v2, s[32:35], s52 offen offset:0 sc1
    buffer_load_dwordx4 v[212:215], v2, s[32:35], s52 offen offset:1024 sc1
    buffer_load_dwordx4 v[216:219], v2, s[32:35], s52 offen offset:2048 sc1
    buffer_load_dwordx4 v[220:223], v2, s[32:35], s52 offen offset:3072 sc1
    s_waitcnt vmcnt(0)
    v_max3_u32 v10, v192, v193, v194
    v_max3_u32 v9, v195, v196, v197
    v_max3_u32 v10, v10, v198, v199
    v_max3_u32 v9, v9, v200, v201
    v_max3_u32 v10, v10, v202, v203
    v_max3_u32 v9, v9, v204, v205
    v_max3_u32 v10, v10, v206, v207
    v_max3_u32 v9, v9, v208, v209
    v_max3_u32 v10, v10, v210, v211
    v_max3_u32 v9, v9, v212, v213
    v_max3_u32 v10, v10, v214, v215
    v_max3_u32 v9, v9, v216, v217
    v_max3_u32 v10, v10, v218, v219
    v_max3_u32 v9, v9, v220, v221
    v_max3_u32 v10, v10, v222, v223
    v_max_u32 v10, v10, v9
    v_cmp_eq_u32 vcc, -1, v10
    s_sub_u32 s62, s62, 1
    s_cbranch_scc1 L_OBD
    s_cbranch_vccnz L_OB2
    s_branch L_OBD
Lnp_9:
    s_mov_b32 s62, 20000
Lnr_64:
    s_sleep 2
    s_mov_b64 exec, 1
    buffer_load_dwordx2 v[6:7], v41, s[52:55], 0 offen sc1
    s_mov_b64 exec, -1
    s_waitcnt vmcnt(0)
    v_readfirstlane_b32 s12, v6
    v_readfirstlane_b32 s13, v7
    s_sub_u32 s62, s62, 1
    s_cbranch_scc1 Lnd_10
    s_cmp_eq_u32 s12, 0
    s_cbranch_scc1 Lnr_64
    s_branch Lnd_10
L_FG:
    s_mov_b64 exec, 1
    buffer_store_dwordx2 v[6:7], v41, s[32:35], s11 offen sc1
    s_mov_b64 exec, 0xff
    s_mov_b32 s62, 20000
L_FG2:
    buffer_load_dwordx2 v[24:25], v42, s[32:35], s16 offen sc1
    s_waitcnt vmcnt(0)
    v_cmp_ne_u64 vcc, s[12:13], v[24:25]
    s_sub_u32 s62, s62, 1
    s_cbranch_scc1 L_F0D
    s_cbranch_vccz L_F0D
    s_sleep 4
    s_branch L_FG2
Lnp_13:
    s_mov_b32 s62, 20000
Lnr_65:
    s_sleep 2
    s_mov_b64 exec, 1
    buffer_load_dwordx2 v[20:21], v13, s[52:55], 0 offen sc1
    s_mov_b64 exec, -1
    s_waitcnt vmcnt(0)
    v_readfirstlane_b32 s12, v20
    v_readfirstlane_b32 s13, v21
    s_sub_u32 s62, s62, 1
    s_cbranch_scc1 Lnd_14
    s_cmp_eq_u32 s12, 0
    s_cbranch_scc1 Lnr_65
    s_branch Lnd_14
Lnp_16:
    s_mov_b32 s62, 20000
Lnr_66:
    s_sleep 2
    s_mov_b64 exec, 1
    buffer_load_dwordx2 v[20:21], v13, s[52:55], 0 offen sc1
    s_mov_b64 exec, -1
    s_waitcnt vmcnt(0)
    v_readfirstlane_b32 s12, v20
    v_readfirstlane_b32 s13, v21
    s_sub_u32 s62, s62, 1
    s_cbranch_scc1 Lnd_17
    s_cmp_eq_u32 s12, 0
    s_cbranch_scc1 Lnr_66
    s_branch Lnd_17
LF1_18:
    s_mov_b32 s62, 20000
    s_mov_b64 exec, 0x3f8
LF1r_20:
    buffer_load_dwordx2 v[12:13], v246, s[32:35], s21 offen sc1
    s_waitcnt vmcnt(0)
    v_cmp_ne_u64 vcc, s[12:13], v[12:13]
    s_sub_u32 s62, s62, 1
    s_cbranch_scc1 LF1r_20x
    s_cbranch_vccnz LF1r_20
LF1r_20x:
    s_mov_b64 exec, -1
    s_branch LF1d_19
Lsy_21:
    s_mov_b32 s62, 320000
Lsy_21r:
    s_sleep 1
    ds_read_b32 v108, v247
    s_waitcnt lgkmcnt(0)
    v_sub_u32 v108, v108, v3
    v_cmp_lt_u32 vcc, 3, v108
    s_sub_u32 s62, s62, 1
    s_cbranch_scc1 Lsyd_22
    s_cbranch_vccnz Lsy_21r
    s_branch Lsyd_22
LF2_23:
    s_mov_b32 s62, 20000
    s_mov_b64 exec, 0xfc00
LF2r_25:
    buffer_load_dwordx2 v[12:13], v246, s[32:35], s21 offen sc1
    s_waitcnt vmcnt(0)
    v_cmp_ne_u64 vcc, s[12:13], v[12:13]
    s_sub_u32 s62, s62, 1
    s_cbranch_scc1 LF2r_25x
    s_cbranch_vccnz LF2r_25
LF2r_25x:
    s_mov_b64 exec, -1
    s_branch LF2d_24
Lsy_31:
    s_mov_b32 s62, 320000
Lsy_31r:
    s_sleep 1
    ds_read_b32 v108, v247
    s_waitcnt lgkmcnt(0)
    v_sub_u32 v108, v3, v108
    v_cmp_eq_u32 vcc, 1, v108
    s_sub_u32 s62, s62, 1
    s_cbranch_scc1 Lsyd_32
    s_cbranch_vccnz Lsy_31r
    s_branch Lsyd_32
LF3_34:
    s_mov_b32 s62, 20000
    s_mov_b64 exec, 0x7f0000
LF3r_36:
    buffer_load_dwordx2 v[12:13], v246, s[32:35], s21 offen sc1
    s_waitcnt vmcnt(0)
    v_cmp_ne_u64 vcc, s[12:13], v[12:13]
    s_sub_u32 s62, s62, 1
    s_cbranch_scc1 LF3r_36x
    s_cbranch_vccnz LF3r_36
LF3r_36x:
    s_mov_b64 exec, -1
    s_branch LF3d_35
LFC_37:
    s_mov_b32 s62, 20000
    s_mov_b64 exec, 0xff
LFCr_39:
    buffer_load_dwordx2 v[14:15], v245, s[32:35], s53 offen sc1
    s_waitcnt vmcnt(0)
    v_cmp_ne_u64 vcc, s[12:13], v[14:15]
    s_sub_u32 s62, s62, 1
    s_cbranch_scc1 LFCr_39x
    s_cbranch_vccnz LFCr_39
LFCr_39x:
    s_mov_b64 exec, -1
    s_branch LFCd_38
Lsy_40:
    s_mov_b32 s62, 320000
Lsy_40r:
    s_sleep 1
    ds_read_b32 v108, v247
    s_waitcnt lgkmcnt(0)
    v_sub_u32 v108, v3, v108
    v_cmp_eq_u32 vcc, 1, v108
    s_sub_u32 s62, s62, 1
    s_cbranch_scc1 Lsyd_41
    s_cbranch_vccnz Lsy_40r
    s_branch Lsyd_41
Lsy_42:
    s_mov_b32 s62, 320000
Lsy_42r:
    s_sleep 1
    ds_read_b32 v108, v247
    s_waitcnt lgkmcnt(0)
    v_sub_u32 v108, v3, v108
    v_cmp_eq_u32 vcc, 1, v108
    s_sub_u32 s62, s62, 1
    s_cbranch_scc1 Lsyd_43
    s_cbranch_vccnz Lsy_42r
    s_branch Lsyd_43
Lcf_44:
    s_nop 7
    v_mov_b32 v32, v157
    v_mov_b32 v33, v157
    v_mov_b32 v34, v157
    v_mov_b32 v35, v157
    v_mov_b32 v36, v157
    v_mov_b32 v37, v157
    v_mov_b32 v38, v157
    v_mov_b32 v39, v157
    v_mov_b32 v40, v157
    v_mov_b32 v41, v157
    v_mov_b32 v42, v157
    v_mov_b32 v43, v157
    v_mov_b32 v44, v157
    v_mov_b32 v45, v157
    v_mov_b32 v46, v157
    v_mov_b32 v47, v157
    s_nop 1
    s_branch Lcb_45
Lcf_46:
    s_nop 7
    v_mov_b32 v32, v157
    v_mov_b32 v33, v157
    v_mov_b32 v34, v157
    v_mov_b32 v35, v157
    v_mov_b32 v36, v157
    v_mov_b32 v37, v157
    v_mov_b32 v38, v157
    v_mov_b32 v39, v157
    v_mov_b32 v40, v157
    v_mov_b32 v41, v157
    v_mov_b32 v42, v157
    v_mov_b32 v43, v157
    v_mov_b32 v44, v157
    v_mov_b32 v45, v157
    v_mov_b32 v46, v157
    v_mov_b32 v47, v157
    s_nop 1
    s_branch Lcb_47
Lcf_48:
    s_nop 7
    v_mov_b32 v32, v157
    v_mov_b32 v33, v157
    v_mov_b32 v34, v157
    v_mov_b32 v35, v157
    v_mov_b32 v36, v157
    v_mov_b32 v37, v157
    v_mov_b32 v38, v157
    v_mov_b32 v39, v157
    v_mov_b32 v40, v157
    v_mov_b32 v41, v157
    v_mov_b32 v42, v157
    v_mov_b32 v43, v157
    v_mov_b32 v44, v157
    v_mov_b32 v45, v157
    v_mov_b32 v46, v157
    v_mov_b32 v47, v157
    s_nop 1
    s_branch Lcb_49
Lfbk_50:
    s_waitcnt lgkmcnt(0)
    v_mov_b32 v228, v120
    v_mov_b32 v232, v120
    v_mov_b32 v229, v121
    v_mov_b32 v233, v121
    v_mov_b32 v230, v122
    v_mov_b32 v234, v122
    v_mov_b32 v231, v123
    v_mov_b32 v235, v123
    v_mov_b32 v236, v157
    v_mov_b32 v238, 0
    v_add_u32 v237, s17, v2
    s_mov_b32 s24, 64
    s_mov_b32 s25, 0
Lsp1_67:
    buffer_load_dwordx4 v[224:227], v237, s[32:35], 0 offen offset:0 sc1
    v_mov_b32 v48, v238
    v_mov_b32 v49, v238
    v_mov_b32 v50, v238
    v_mov_b32 v51, v238
    v_mov_b32 v52, v238
    v_mov_b32 v53, v238
    v_mov_b32 v54, v238
    v_mov_b32 v55, v238
    v_mov_b32 v56, v238
    v_mov_b32 v57, v238
    v_mov_b32 v58, v238
    v_mov_b32 v59, v238
    v_mov_b32 v60, v238
    v_mov_b32 v61, v238
    v_mov_b32 v62, v238
    v_mov_b32 v63, v238
    s_waitcnt vmcnt(0) lgkmcnt(0)
    s_nop 1
    v_mfma_f32_32x32x16_bf16 v[192:207], v[224:227], v[8:11], v[48:63]
    s_nop 15
    v_max3_f32 v236, v236, v192, v193
    v_max3_f32 v236, v236, v194, v195
    v_max3_f32 v236, v236, v196, v197
    v_max3_f32 v236, v236, v198, v199
    v_max3_f32 v236, v236, v200, v201
    v_max3_f32 v236, v236, v202, v203
    v_max3_f32 v236, v236, v204, v205
    v_max3_f32 v236, v236, v206, v207
    v_add_u32 v237, 2048, v237
    s_add_u32 s25, s25, 1
    s_cmp_lt_u32 s25, s24
    s_cbranch_scc1 Lsp1_67
    v_mov_b32 v239, v236
    s_nop 1
    v_permlane32_swap_b32 v236, v239
    s_nop 1
    v_max_f32 v236, v236, v239
    v_sub_f32 v238, 0, v236
    v_mov_b32 v176, 0
    v_mov_b32 v177, 0
    v_mov_b32 v178, 0
    v_mov_b32 v179, 0
    v_mov_b32 v180, 0
    v_mov_b32 v181, 0
    v_mov_b32 v182, 0
    v_mov_b32 v183, 0
    v_mov_b32 v184, 0
    v_mov_b32 v185, 0
    v_mov_b32 v186, 0
    v_mov_b32 v187, 0
    v_mov_b32 v188, 0
    v_mov_b32 v189, 0
    v_mov_b32 v190, 0
    v_mov_b32 v191, 0
    v_add_u32 v237, s17, v2
    s_mov_b32 s24, 64
    s_mov_b32 s25, 0
Lsp2_68:
    buffer_load_dwordx4 v[224:227], v237, s[32:35], 0 offen offset:0 sc1
    s_mov_b64 exec, s[56:57]
    buffer_load_dwordx4 v[228:231], v237, s[32:35], 0 offen offset:1024 sc1
    buffer_load_dwordx4 v[232:235], v237, s[32:35], 0 offen offset:1280 sc1
    s_mov_b64 exec, -1
    v_mov_b32 v48, v238
    v_mov_b32 v49, v238
    v_mov_b32 v50, v238
    v_mov_b32 v51, v238
    v_mov_b32 v52, v238
    v_mov_b32 v53, v238
    v_mov_b32 v54, v238
    v_mov_b32 v55, v238
    v_mov_b32 v56, v238
    v_mov_b32 v57, v238
    v_mov_b32 v58, v238
    v_mov_b32 v59, v238
    v_mov_b32 v60, v238
    v_mov_b32 v61, v238
    v_mov_b32 v62, v238
    v_mov_b32 v63, v238
    s_waitcnt vmcnt(0) lgkmcnt(0)
    s_nop 1
    v_mfma_f32_32x32x16_bf16 v[192:207], v[224:227], v[8:11], v[48:63]
    s_nop 15
    v_exp_f32 v192, v192
    v_exp_f32 v193, v193
    v_exp_f32 v194, v194
    v_exp_f32 v195, v195
    v_exp_f32 v196, v196
    v_exp_f32 v197, v197
    v_exp_f32 v198, v198
    v_exp_f32 v199, v199
    v_exp_f32 v200, v200
    v_exp_f32 v201, v201
    v_exp_f32 v202, v202
    v_exp_f32 v203, v203
    v_exp_f32 v204, v204
    v_exp_f32 v205, v205
    v_exp_f32 v206, v206
    v_exp_f32 v207, v207
    s_nop 2
    v_smfmac_f32_32x32x32_bf16 v[176:191], v[228:231], v[192:199], v152
    v_smfmac_f32_32x32x32_bf16 v[176:191], v[232:235], v[200:207], v152
    s_nop 7
    v_add_u32 v237, 2048, v237
    s_add_u32 s25, s25, 1
    s_cmp_lt_u32 s25, s24
    s_cbranch_scc1 Lsp2_68
    s_nop 15
    v_rcp_f32 v106, v184
    v_sub_f32 v107, 1.0, v155
    v_mul_f32 v106, v106, v107
    v_pk_mul_f32 v[176:177], v[176:177], v[106:107] op_sel_hi:[1,0]
    v_pk_mul_f32 v[178:179], v[178:179], v[106:107] op_sel_hi:[1,0]
    v_pk_mul_f32 v[180:181], v[180:181], v[106:107] op_sel_hi:[1,0]
    v_pk_mul_f32 v[182:183], v[182:183], v[106:107] op_sel_hi:[1,0]
    v_cvt_pk_bf16_f32 v188, v176, v177
    v_cvt_pk_bf16_f32 v189, v178, v179
    v_cvt_pk_bf16_f32 v190, v180, v181
    v_cvt_pk_bf16_f32 v191, v182, v183
    s_branch Lfok_51
Lcf_52:
    s_nop 7
    v_mov_b32 v32, v157
    v_mov_b32 v33, v157
    v_mov_b32 v34, v157
    v_mov_b32 v35, v157
    v_mov_b32 v36, v157
    v_mov_b32 v37, v157
    v_mov_b32 v38, v157
    v_mov_b32 v39, v157
    v_mov_b32 v40, v157
    v_mov_b32 v41, v157
    v_mov_b32 v42, v157
    v_mov_b32 v43, v157
    v_mov_b32 v44, v157
    v_mov_b32 v45, v157
    v_mov_b32 v46, v157
    v_mov_b32 v47, v157
    s_nop 1
    s_branch Lcb_53
Lcf_54:
    s_nop 7
    v_mov_b32 v32, v157
    v_mov_b32 v33, v157
    v_mov_b32 v34, v157
    v_mov_b32 v35, v157
    v_mov_b32 v36, v157
    v_mov_b32 v37, v157
    v_mov_b32 v38, v157
    v_mov_b32 v39, v157
    v_mov_b32 v40, v157
    v_mov_b32 v41, v157
    v_mov_b32 v42, v157
    v_mov_b32 v43, v157
    v_mov_b32 v44, v157
    v_mov_b32 v45, v157
    v_mov_b32 v46, v157
    v_mov_b32 v47, v157
    s_nop 1
    s_branch Lcb_55
Lcf_56:
    s_nop 7
    v_mov_b32 v32, v157
    v_mov_b32 v33, v157
    v_mov_b32 v34, v157
    v_mov_b32 v35, v157
    v_mov_b32 v36, v157
    v_mov_b32 v37, v157
    v_mov_b32 v38, v157
    v_mov_b32 v39, v157
    v_mov_b32 v40, v157
    v_mov_b32 v41, v157
    v_mov_b32 v42, v157
    v_mov_b32 v43, v157
    v_mov_b32 v44, v157
    v_mov_b32 v45, v157
    v_mov_b32 v46, v157
    v_mov_b32 v47, v157
    s_nop 1
    s_branch Lcb_57
Lcf_58:
    s_nop 7
    v_mov_b32 v32, v157
    v_mov_b32 v33, v157
    v_mov_b32 v34, v157
    v_mov_b32 v35, v157
    v_mov_b32 v36, v157
    v_mov_b32 v37, v157
    v_mov_b32 v38, v157
    v_mov_b32 v39, v157
    v_mov_b32 v40, v157
    v_mov_b32 v41, v157
    v_mov_b32 v42, v157
    v_mov_b32 v43, v157
    v_mov_b32 v44, v157
    v_mov_b32 v45, v157
    v_mov_b32 v46, v157
    v_mov_b32 v47, v157
    s_nop 1
    s_branch Lcb_59
Lff_60:
    v_mov_b32 v136, v157
    v_mov_b32 v137, v157
    v_mov_b32 v138, v157
    v_mov_b32 v139, v157
    v_mov_b32 v140, v157
    v_mov_b32 v141, v157
    v_mov_b32 v142, v157
    v_mov_b32 v143, v157
    v_mov_b32 v144, v157
    v_mov_b32 v145, v157
    v_mov_b32 v146, v157
    v_mov_b32 v147, v157
    v_mov_b32 v148, v157
    v_mov_b32 v149, v157
    v_mov_b32 v150, v157
    v_mov_b32 v151, v157
    s_branch Lfk_61
Lfbk_62:
    s_waitcnt lgkmcnt(0)
    v_mov_b32 v228, v120
    v_mov_b32 v232, v120
    v_mov_b32 v229, v121
    v_mov_b32 v233, v121
    v_mov_b32 v230, v122
    v_mov_b32 v234, v122
    v_mov_b32 v231, v123
    v_mov_b32 v235, v123
    v_mov_b32 v236, v157
    v_mov_b32 v238, 0
    v_add_u32 v237, 16384, v154
    s_min_u32 s24, s10, 8
    s_add_u32 s24, s24, 1
    s_mov_b32 s25, 0
Lsp1_69:
    ds_read_b128 v[224:227], v237 offset:0
    s_cmp_lg_u32 s25, 8
    s_cselect_b64 s[26:27], -1, 0
    s_cmp_lg_u32 s25, 0
    s_cselect_b64 s[28:29], -1, 0
    s_and_b64 s[30:31], s[64:65], s[26:27]
    s_andn2_b64 vcc, s[28:29], s[64:65]
    s_or_b64 vcc, vcc, s[30:31]
    v_cndmask_b32 v136, v157, v238, vcc
    s_and_b64 s[30:31], s[66:67], s[26:27]
    s_andn2_b64 vcc, s[28:29], s[66:67]
    s_or_b64 vcc, vcc, s[30:31]
    v_cndmask_b32 v137, v157, v238, vcc
    s_and_b64 s[30:31], s[68:69], s[26:27]
    s_andn2_b64 vcc, s[28:29], s[68:69]
    s_or_b64 vcc, vcc, s[30:31]
    v_cndmask_b32 v138, v157, v238, vcc
    s_and_b64 s[30:31], s[70:71], s[26:27]
    s_andn2_b64 vcc, s[28:29], s[70:71]
    s_or_b64 vcc, vcc, s[30:31]
    v_cndmask_b32 v139, v157, v238, vcc
    s_and_b64 s[30:31], s[72:73], s[26:27]
    s_andn2_b64 vcc, s[28:29], s[72:73]
    s_or_b64 vcc, vcc, s[30:31]
    v_cndmask_b32 v140, v157, v238, vcc
    s_and_b64 s[30:31], s[74:75], s[26:27]
    s_andn2_b64 vcc, s[28:29], s[74:75]
    s_or_b64 vcc, vcc, s[30:31]
    v_cndmask_b32 v141, v157, v238, vcc
    s_and_b64 s[30:31], s[76:77], s[26:27]
    s_andn2_b64 vcc, s[28:29], s[76:77]
    s_or_b64 vcc, vcc, s[30:31]
    v_cndmask_b32 v142, v157, v238, vcc
    s_and_b64 s[30:31], s[78:79], s[26:27]
    s_andn2_b64 vcc, s[28:29], s[78:79]
    s_or_b64 vcc, vcc, s[30:31]
    v_cndmask_b32 v143, v157, v238, vcc
    s_and_b64 s[30:31], s[80:81], s[26:27]
    s_andn2_b64 vcc, s[28:29], s[80:81]
    s_or_b64 vcc, vcc, s[30:31]
    v_cndmask_b32 v144, v157, v238, vcc
    s_and_b64 s[30:31], s[82:83], s[26:27]
    s_andn2_b64 vcc, s[28:29], s[82:83]
    s_or_b64 vcc, vcc, s[30:31]
    v_cndmask_b32 v145, v157, v238, vcc
    s_and_b64 s[30:31], s[84:85], s[26:27]
    s_andn2_b64 vcc, s[28:29], s[84:85]
    s_or_b64 vcc, vcc, s[30:31]
    v_cndmask_b32 v146, v157, v238, vcc
    s_and_b64 s[30:31], s[86:87], s[26:27]
    s_andn2_b64 vcc, s[28:29], s[86:87]
    s_or_b64 vcc, vcc, s[30:31]
    v_cndmask_b32 v147, v157, v238, vcc
    s_and_b64 s[30:31], s[88:89], s[26:27]
    s_andn2_b64 vcc, s[28:29], s[88:89]
    s_or_b64 vcc, vcc, s[30:31]
    v_cndmask_b32 v148, v157, v238, vcc
    s_and_b64 s[30:31], s[90:91], s[26:27]
    s_andn2_b64 vcc, s[28:29], s[90:91]
    s_or_b64 vcc, vcc, s[30:31]
    v_cndmask_b32 v149, v157, v238, vcc
    s_and_b64 s[30:31], s[92:93], s[26:27]
    s_andn2_b64 vcc, s[28:29], s[92:93]
    s_or_b64 vcc, vcc, s[30:31]
    v_cndmask_b32 v150, v157, v238, vcc
    s_and_b64 s[30:31], s[94:95], s[26:27]
    s_andn2_b64 vcc, s[28:29], s[94:95]
    s_or_b64 vcc, vcc, s[30:31]
    v_cndmask_b32 v151, v157, v238, vcc
    s_waitcnt vmcnt(0) lgkmcnt(0)
    s_nop 1
    v_mfma_f32_32x32x16_bf16 v[48:63], v[224:227], v[4:7], v[136:151]
    s_nop 15
    v_max3_f32 v236, v236, v48, v49
    v_max3_f32 v236, v236, v50, v51
    v_max3_f32 v236, v236, v52, v53
    v_max3_f32 v236, v236, v54, v55
    v_max3_f32 v236, v236, v56, v57
    v_max3_f32 v236, v236, v58, v59
    v_max3_f32 v236, v236, v60, v61
    v_max3_f32 v236, v236, v62, v63
    v_subrev_u32 v237, 2048, v237
    s_add_u32 s25, s25, 1
    s_cmp_lt_u32 s25, s24
    s_cbranch_scc1 Lsp1_69
    v_mov_b32 v239, v236
    s_nop 1
    v_permlane32_swap_b32 v236, v239
    s_nop 1
    v_max_f32 v236, v236, v239
    v_sub_f32 v238, 0, v236
    v_mov_b32 v160, 0
    v_mov_b32 v161, 0
    v_mov_b32 v162, 0
    v_mov_b32 v163, 0
    v_mov_b32 v164, 0
    v_mov_b32 v165, 0
    v_mov_b32 v166, 0
    v_mov_b32 v167, 0
    v_mov_b32 v168, 0
    v_mov_b32 v169, 0
    v_mov_b32 v170, 0
    v_mov_b32 v171, 0
    v_mov_b32 v172, 0
    v_mov_b32 v173, 0
    v_mov_b32 v174, 0
    v_mov_b32 v175, 0
    v_add_u32 v237, 16384, v154
    s_min_u32 s24, s10, 8
    s_add_u32 s24, s24, 1
    s_mov_b32 s25, 0
Lsp2_70:
    ds_read_b128 v[224:227], v237 offset:0
    s_mov_b64 exec, s[56:57]
    ds_read_b128 v[228:231], v237 offset:1024
    ds_read_b128 v[232:235], v237 offset:1280
    s_mov_b64 exec, -1
    s_cmp_lg_u32 s25, 8
    s_cselect_b64 s[26:27], -1, 0
    s_cmp_lg_u32 s25, 0
    s_cselect_b64 s[28:29], -1, 0
    s_and_b64 s[30:31], s[64:65], s[26:27]
    s_andn2_b64 vcc, s[28:29], s[64:65]
    s_or_b64 vcc, vcc, s[30:31]
    v_cndmask_b32 v136, v157, v238, vcc
    s_and_b64 s[30:31], s[66:67], s[26:27]
    s_andn2_b64 vcc, s[28:29], s[66:67]
    s_or_b64 vcc, vcc, s[30:31]
    v_cndmask_b32 v137, v157, v238, vcc
    s_and_b64 s[30:31], s[68:69], s[26:27]
    s_andn2_b64 vcc, s[28:29], s[68:69]
    s_or_b64 vcc, vcc, s[30:31]
    v_cndmask_b32 v138, v157, v238, vcc
    s_and_b64 s[30:31], s[70:71], s[26:27]
    s_andn2_b64 vcc, s[28:29], s[70:71]
    s_or_b64 vcc, vcc, s[30:31]
    v_cndmask_b32 v139, v157, v238, vcc
    s_and_b64 s[30:31], s[72:73], s[26:27]
    s_andn2_b64 vcc, s[28:29], s[72:73]
    s_or_b64 vcc, vcc, s[30:31]
    v_cndmask_b32 v140, v157, v238, vcc
    s_and_b64 s[30:31], s[74:75], s[26:27]
    s_andn2_b64 vcc, s[28:29], s[74:75]
    s_or_b64 vcc, vcc, s[30:31]
    v_cndmask_b32 v141, v157, v238, vcc
    s_and_b64 s[30:31], s[76:77], s[26:27]
    s_andn2_b64 vcc, s[28:29], s[76:77]
    s_or_b64 vcc, vcc, s[30:31]
    v_cndmask_b32 v142, v157, v238, vcc
    s_and_b64 s[30:31], s[78:79], s[26:27]
    s_andn2_b64 vcc, s[28:29], s[78:79]
    s_or_b64 vcc, vcc, s[30:31]
    v_cndmask_b32 v143, v157, v238, vcc
    s_and_b64 s[30:31], s[80:81], s[26:27]
    s_andn2_b64 vcc, s[28:29], s[80:81]
    s_or_b64 vcc, vcc, s[30:31]
    v_cndmask_b32 v144, v157, v238, vcc
    s_and_b64 s[30:31], s[82:83], s[26:27]
    s_andn2_b64 vcc, s[28:29], s[82:83]
    s_or_b64 vcc, vcc, s[30:31]
    v_cndmask_b32 v145, v157, v238, vcc
    s_and_b64 s[30:31], s[84:85], s[26:27]
    s_andn2_b64 vcc, s[28:29], s[84:85]
    s_or_b64 vcc, vcc, s[30:31]
    v_cndmask_b32 v146, v157, v238, vcc
    s_and_b64 s[30:31], s[86:87], s[26:27]
    s_andn2_b64 vcc, s[28:29], s[86:87]
    s_or_b64 vcc, vcc, s[30:31]
    v_cndmask_b32 v147, v157, v238, vcc
    s_and_b64 s[30:31], s[88:89], s[26:27]
    s_andn2_b64 vcc, s[28:29], s[88:89]
    s_or_b64 vcc, vcc, s[30:31]
    v_cndmask_b32 v148, v157, v238, vcc
    s_and_b64 s[30:31], s[90:91], s[26:27]
    s_andn2_b64 vcc, s[28:29], s[90:91]
    s_or_b64 vcc, vcc, s[30:31]
    v_cndmask_b32 v149, v157, v238, vcc
    s_and_b64 s[30:31], s[92:93], s[26:27]
    s_andn2_b64 vcc, s[28:29], s[92:93]
    s_or_b64 vcc, vcc, s[30:31]
    v_cndmask_b32 v150, v157, v238, vcc
    s_and_b64 s[30:31], s[94:95], s[26:27]
    s_andn2_b64 vcc, s[28:29], s[94:95]
    s_or_b64 vcc, vcc, s[30:31]
    v_cndmask_b32 v151, v157, v238, vcc
    s_waitcnt vmcnt(0) lgkmcnt(0)
    s_nop 1
    v_mfma_f32_32x32x16_bf16 v[48:63], v[224:227], v[4:7], v[136:151]
    s_nop 15
    v_exp_f32 v48, v48
    v_exp_f32 v49, v49
    v_exp_f32 v50, v50
    v_exp_f32 v51, v51
    v_exp_f32 v52, v52
    v_exp_f32 v53, v53
    v_exp_f32 v54, v54
    v_exp_f32 v55, v55
    v_exp_f32 v56, v56
    v_exp_f32 v57, v57
    v_exp_f32 v58, v58
    v_exp_f32 v59, v59
    v_exp_f32 v60, v60
    v_exp_f32 v61, v61
    v_exp_f32 v62, v62
    v_exp_f32 v63, v63
    s_nop 2
    v_smfmac_f32_32x32x32_bf16 v[160:175], v[228:231], v[48:55], v152
    v_smfmac_f32_32x32x32_bf16 v[160:175], v[232:235], v[56:63], v152
    s_nop 7
    v_subrev_u32 v237, 2048, v237
    s_add_u32 s25, s25, 1
    s_cmp_lt_u32 s25, s24
    s_cbranch_scc1 Lsp2_70
    s_nop 15
    v_rcp_f32 v106, v168
    v_mov_b32 v107, v155
    v_mul_f32 v106, v106, v107
    v_pk_mul_f32 v[160:161], v[160:161], v[106:107] op_sel_hi:[1,0]
    v_pk_mul_f32 v[162:163], v[162:163], v[106:107] op_sel_hi:[1,0]
    v_pk_mul_f32 v[164:165], v[164:165], v[106:107] op_sel_hi:[1,0]
    v_pk_mul_f32 v[166:167], v[166:167], v[106:107] op_sel_hi:[1,0]
    v_cvt_pk_bf16_f32 v172, v160, v161
    v_cvt_pk_bf16_f32 v173, v162, v163
    v_cvt_pk_bf16_f32 v174, v164, v165
    v_cvt_pk_bf16_f32 v175, v166, v167
    s_branch Lfok_63
.section .rodata,"a"
.p2align 6
.amdhsa_kernel gated_mix__sliding_block__softmax_full_mha__prompt_kernel
  .amdhsa_next_free_vgpr 256
  .amdhsa_next_free_sgpr 102
  .amdhsa_accum_offset 256
  .amdhsa_group_segment_fixed_size 0
  .amdhsa_kernarg_size 80
  .amdhsa_user_sgpr_count 2
  .amdhsa_user_sgpr_kernarg_segment_ptr 1
  .amdhsa_system_sgpr_workgroup_id_x 1
.end_amdhsa_kernel
```
